```python
import torch

def _softmax(x, axis=-1):
    return torch.softmax(x, dim=axis)
def _gelu(x):
    return torch.nn.functional.gelu(x, approximate="tanh")
def _silu(x):
    return torch.nn.functional.silu(x)
def _sigmoid(x):
    return torch.sigmoid(x)
def _layernorm(x, axis=-1, eps=1e-5):
    m = x.mean(dim=axis, keepdim=True)
    v = x.var(dim=axis, keepdim=True, unbiased=False)
    return (x - m) / torch.sqrt(v + eps)
def _scatter_add(tgt, idx, src, axis=0):
    return tgt.clone().index_add_(axis, idx, src)
def _segment_sum(src, seg, n):
    out = torch.zeros((n,) + src.shape[1:], dtype=src.dtype)
    return out.index_add_(0, seg, src)
def _pad(x, pw):
    flat = tuple(v for pair in reversed(pw) for v in pair)
    return torch.nn.functional.pad(x, flat)

kernel_name = 'gated_mix__mha_block_cached__geglu_ffn__decode'

def setup_inputs():

    _w = (lambda a: (lambda t: t.to(torch.bfloat16) if t.is_floating_point() else t)(torch.as_tensor(a)))
    def _A_setup():
        B, Sq, D = 2, 1, 512
        H, Sk, Dh = 32, 4096, 128
        return {
            "x": _w((lambda *s: torch.randn(*s, dtype=torch.bfloat16) * 0.05)(B, Sq, D)),
            "k_cache": _w((lambda *s: torch.randn(*s, dtype=torch.bfloat16) * 3.2)(B, H, Sk, Dh)),
            "v_cache": _w((lambda *s: torch.randn(*s, dtype=torch.bfloat16) * 0.8)(B, H, Sk, Dh)),
            "wq": _w((lambda *s: torch.randn(*s, dtype=torch.bfloat16) * 3.2)(D, H * Dh) * (D ** -0.5)),
            "wo": _w((lambda *s: torch.randn(*s, dtype=torch.bfloat16) * 0.8)(H * Dh, D) * ((H * Dh) ** -0.5)),
        }
    _A_in = _A_setup()

    def _B_setup():
        B, S, D, F = 2, 1, 512, 1376
        return {
            "x": _w((lambda *s: torch.randn(*s, dtype=torch.bfloat16) * 0.05)(B, S, D)),
            "w_gate": _w((lambda *s: torch.randn(*s, dtype=torch.bfloat16) * 0.05)(D, F)),
            "w_up": _w((lambda *s: torch.randn(*s, dtype=torch.bfloat16) * 0.05)(D, F)),
            "w_down": _w((lambda *s: torch.randn(*s, dtype=torch.bfloat16) * 0.05)(F, D)),
        }
    _B_in = _B_setup()

    return {
        "A_x": _A_in["x"],
        "A_k_cache": _A_in["k_cache"],
        "A_v_cache": _A_in["v_cache"],
        "A_wq": _A_in["wq"],
        "A_wo": _A_in["wo"],
        "B_x": _B_in["x"],
        "B_w_gate": _B_in["w_gate"],
        "B_w_up": _B_in["w_up"],
        "B_w_down": _B_in["w_down"],
        "gate_w": _w((lambda *s: torch.randn(*s, dtype=torch.bfloat16) * 0.05)(512) * 16.0),
    }

def reference(A_x, A_k_cache, A_v_cache, A_wq, A_wo, B_x, B_w_gate, B_w_up, B_w_down, gate_w):
    def _A_ref(x, k_cache, v_cache, wq, wo):
        B, Sq, D = x.shape
        H, Dh = 32, 128
        q = (lambda x, *d: x.permute(*d))((x @ wq).reshape(B, Sq, H, Dh), 0, 2, 1, 3)
        scores = torch.einsum("bhqd,bhkd->bhqk", q, k_cache) * (Dh ** -0.5)
        p = _softmax(scores, axis=-1)
        o = torch.einsum("bhqk,bhkd->bhqd", p, v_cache)
        return (lambda x, *d: x.permute(*d))(o, 0, 2, 1, 3).reshape(B, Sq, H * Dh) @ wo

    def _B_ref(x, w_gate, w_up, w_down):
        return (_gelu(x @ w_gate) * (x @ w_up)) @ w_down

    x = A_x
    g = _sigmoid((x * gate_w).sum(-1, keepdims=True))
    a = _A_ref(x, A_k_cache, A_v_cache, A_wq, A_wo)
    b = _B_ref(x, B_w_gate, B_w_up, B_w_down)
    return g * a + (1 - g) * b
```

```asm
; @launch grid=(256,1,1) block=(256,1,1) lds=49152
.amdgcn_target "amdgcn-amd-amdhsa--gfx950"
.text
.globl gated_mix__mha_block_cached__geglu_ffn__decode_kernel
.p2align 8
.type gated_mix__mha_block_cached__geglu_ffn__decode_kernel,@function
gated_mix__mha_block_cached__geglu_ffn__decode_kernel:
    s_lshr_b32 s3, s2, 8
    s_cbranch_scc1 L_end
    s_load_dwordx2 s[8:9], s[0:1], 8
    s_load_dwordx2 s[36:37], s[0:1], 96
    s_bfe_u32 s57, s2, 0x40003
    s_and_b32 s58, s2, 7
    s_lshl4_add_u32 s56, s58, s57
    s_and_b32 s59, s2, 0x80
    s_add_u32 s59, s59, s56
    v_lshlrev_b32 v1, 4, v0
    v_and_b32 v44, 0xc0, v0
    v_mad_u32_u24 v1, v44, 48, v1
    s_lshl_b32 s10, 1, 26
    v_lshl_add_u32 v1, s59, 18, v1
    s_mov_b32 s11, 0x20000
    s_waitcnt lgkmcnt(0)
    buffer_load_dwordx4 v[64:67], v1, s[8:11], s3 offen offset:0 nt
    buffer_load_dwordx4 v[68:71], v1, s[8:11], s3 offen offset:1024 nt
    buffer_load_dwordx4 v[72:75], v1, s[8:11], s3 offen offset:2048 nt
    buffer_load_dwordx4 v[76:79], v1, s[8:11], s3 offen offset:3072 nt
    s_load_dwordx16 s[64:79], s[0:1], 0
    s_load_dwordx8 s[80:87], s[0:1], 64
    s_lshr_b32 s52, s56, 2
    s_and_b32 s54, s56, 3
    s_lshr_b32 s53, s2, 7
    s_lshr_b32 s55, s59, 2
    s_mov_b32 s6, 2048
    s_mov_b32 s38, 2621440
    s_mov_b32 s7, 0x20000
    s_mov_b32 s19, 0x20000
    s_mov_b32 s39, 0x20000
    s_and_b32 s46, s2, 1
    s_bfe_u32 s57, s2, 0x20001
    s_lshr_b32 s58, s2, 3
    s_mul_i32 s49, s57, 22
    s_lshl_b32 s57, s57, 5
    s_cmp_eq_u32 s46, 0
    s_cselect_b32 s49, s57, s49
    s_add_u32 s49, s49, s58
    s_cmp_lt_u32 s58, 22
    s_cselect_b32 s18, 1409024, 0
    s_lshr_b32 s42, s49, 2
    s_and_b32 s51, s49, 3
    s_lshl_b32 s58, s46, 7
    s_add_u32 s49, s49, s58
    s_cmp_ge_u32 s42, 11
    s_cselect_b32 s57, 11, 0
    s_sub_u32 s57, s42, s57
    s_mov_b32 s43, 2752
    s_cmp_eq_u32 s46, 0
    s_cselect_b32 s18, 4194304, s18
    s_cselect_b32 s43, 8192, s43
    s_cselect_b32 s57, s42, s57
    s_lshl_b32 s57, s57, 8
    v_and_b32 v46, 15, v0
    v_lshrrev_b32 v15, 4, v0
    v_lshlrev_b32 v15, 3, v15
    s_lshl_b32 s58, s51, 7
    v_add_u32 v15, s58, v15
    v_mul_u32_u24 v2, s43, v15
    v_lshl_add_u32 v2, v46, 4, v2
    v_add_u32 v2, s57, v2
    v_bfe_u32 v11, v0, 3, 1
    v_lshlrev_b32 v11, 10, v11
    v_lshl_add_u32 v11, v15, 1, v11
    s_mov_b32 s59, 131072
    s_waitcnt lgkmcnt(0)
    buffer_load_dwordx2 v[18:19], off, s[36:39], s59 sc1
    s_cmp_ge_u32 s42, 11
    s_cselect_b32 s16, s78, s76
    s_cselect_b32 s17, s79, s77
    s_cmp_eq_u32 s46, 0
    s_cselect_b32 s16, s70, s16
    s_cselect_b32 s17, s71, s17
    s_mov_b32 s4, s64
    s_mov_b32 s5, s65
    buffer_load_dwordx4 v[24:27], v11, s[4:7], 0 offen
    buffer_load_dwordx4 a[224:227], v2, s[16:19], 0 offen nt
    buffer_load_dwordx4 a[228:231], v2, s[16:19], s43 offen nt
    s_lshl_b32 s59, s43, 1
    buffer_load_dwordx4 a[232:235], v2, s[16:19], s59 offen nt
    s_add_u32 s59, s59, s43
    buffer_load_dwordx4 a[236:239], v2, s[16:19], s59 offen nt
    s_add_u32 s59, s59, s43
    buffer_load_dwordx4 a[240:243], v2, s[16:19], s59 offen nt
    s_add_u32 s59, s59, s43
    buffer_load_dwordx4 a[244:247], v2, s[16:19], s59 offen nt
    s_add_u32 s59, s59, s43
    buffer_load_dwordx4 a[248:251], v2, s[16:19], s59 offen nt
    s_add_u32 s59, s59, s43
    buffer_load_dwordx4 a[252:255], v2, s[16:19], s59 offen nt
    s_mov_b32 s3, 16384
    buffer_load_dwordx4 v[80:83], v1, s[8:11], s3 offen offset:0 nt
    s_mov_b32 s14, 67108864
    s_mov_b32 s22, 4194304
    s_mov_b32 s26, 1409024
    s_mov_b32 s30, 1024
    s_mov_b32 s34, 2048
    s_mov_b32 s15, 0x20000
    s_mov_b32 s23, 0x20000
    s_mov_b32 s27, 0x20000
    s_mov_b32 s31, 0x20000
    s_mov_b32 s35, 0x20000
    v_and_b32 v44, 63, v0
    v_lshrrev_b32 v45, 6, v0
    v_bfe_u32 v47, v0, 4, 2
    v_readfirstlane_b32 s47, v0
    s_mov_b32 s12, s68
    s_mov_b32 s13, s69
    s_mov_b32 s20, s72
    s_mov_b32 s21, s73
    s_mov_b32 s24, s80
    s_mov_b32 s25, s81
    s_mov_b32 s28, s82
    s_mov_b32 s29, s83
    s_mov_b32 s32, s84
    s_mov_b32 s33, s85
    v_and_b32 v15, 1, v0
    v_cmp_eq_u32 vcc, 1, v15
    v_mov_b32 v15, 0xffff
    v_mov_b32 v11, 0xffff0000
    v_cndmask_b32 v15, v15, v11, vcc
    v_bfe_u32 v11, v0, 1, 2
    v_cmp_eq_u32 vcc, 0, v11
    s_nop 1
    v_cndmask_b32 v20, 0, v15, vcc
    v_cmp_eq_u32 vcc, 1, v11
    s_nop 1
    v_cndmask_b32 v21, 0, v15, vcc
    v_cmp_eq_u32 vcc, 2, v11
    s_nop 1
    v_cndmask_b32 v22, 0, v15, vcc
    v_cmp_eq_u32 vcc, 3, v11
    s_nop 1
    v_cndmask_b32 v23, 0, v15, vcc
    s_mov_b32 s44, 0x01000100
    s_mov_b32 s45, 0x03020302
    s_mov_b32 s48, 0xffffff00
    s_mov_b32 s89, 0xfff
    s_mov_b32 s88, 0xfffff000
    s_lshl_b32 s40, s53, 7
    s_add_u32 s40, s40, s56
    s_lshr_b32 s57, s40, 5
    s_lshl_b32 s57, s57, 18
    s_and_b32 s40, s40, 31
    s_lshl_b32 s40, s40, 11
    s_add_u32 s40, s40, s57
    s_and_b32 s57, s55, 1
    s_lshl_b32 s57, s57, 20
    s_lshr_b32 s41, s55, 1
    s_lshl_b32 s41, s41, 7
    s_add_u32 s41, s41, s57
    s_add_u32 s41, s41, 98304
    v_mov_b32 v7, 1073741824
    v_lshlrev_b32 v6, 3, v0
    v_add_u32 v6, s40, v6
    v_mul_u32_u24 v9, 320, v45
    v_lshl_add_u32 v9, v46, 4, v9
    v_lshl_add_u32 v9, v47, 3, v9
    v_and_b32 v8, 3, v0
    v_lshlrev_b32 v8, 18, v8
    v_add_u32 v8, s41, v8
    v_lshlrev_b32 v5, 8, v45
    v_lshl_add_u32 v5, v46, 4, v5
    v_lshl_add_u32 v3, v47, 10, v5
    s_lshl_b32 s59, s52, 17
    v_add_u32 v3, s59, v3
    v_lshl_add_u32 v5, v47, 12, v5
    s_mul_i32 s59, s56, 12288
    v_add_u32 v5, s59, v5
    v_cmp_gt_u32 s[62:63], 3, v47
    s_nop 1
    v_cndmask_b32 v5, v7, v5, s[62:63]
    v_and_b32 v15, 3, v0
    v_lshl_add_u32 v15, v47, 2, v15
    s_mul_i32 s57, s56, 12
    v_add_u32 v15, s57, v15
    v_mov_b32 v11, 1376
    v_cmp_lt_u32 vcc, v15, v11
    s_nop 0
    s_and_b64 s[62:63], s[62:63], vcc
    v_bfe_u32 v36, v0, 2, 2
    v_lshlrev_b32 v36, 18, v36
    v_bfe_u32 v11, v15, 2, 1
    v_lshl_add_u32 v36, v11, 8, v36
    v_bfe_u32 v11, v15, 3, 4
    v_lshl_add_u32 v36, v11, 4, v36
    v_and_b32 v11, 3, v15
    v_lshl_add_u32 v36, v11, 2, v36
    s_lshl_b32 s57, s53, 9
    s_add_u32 s57, s57, 81920
    v_add_u32 v36, s57, v36
    v_lshrrev_b32 v15, 7, v15
    v_and_b32 v11, 1, v15
    v_lshl_add_u32 v4, v11, 20, v36
    v_lshrrev_b32 v11, 1, v15
    v_lshl_add_u32 v4, v11, 10, v4
    v_cndmask_b32 v4, v7, v4, s[62:63]
    v_add_u32 v15, 11, v15
    v_and_b32 v11, 1, v15
    v_lshl_add_u32 v43, v11, 20, v36
    v_lshrrev_b32 v11, 1, v15
    v_lshl_add_u32 v43, v11, 10, v43
    v_cndmask_b32 v43, v7, v43, s[62:63]
    s_and_b32 s57, s49, 7
    s_lshl_b32 s57, s57, 18
    s_lshr_b32 s58, s49, 3
    s_lshl_b32 s58, s58, 10
    s_add_u32 s57, s57, s58
    s_add_u32 s57, s57, 65536
    s_cmp_eq_u32 s18, 0
    s_cselect_b32 s57, 1073741824, s57
    v_lshlrev_b32 v13, 4, v44
    v_add_u32 v13, s57, v13
    s_lshl_b32 s57, s54, 18
    s_add_u32 s57, s57, s41
    v_lshl_add_u32 v15, v44, 4, s57
    v_cmp_gt_u32 vcc, 8, v44
    s_nop 1
    v_cndmask_b32 v7, v7, v15, vcc
    s_lshl_b32 s57, s54, 8
    s_or_b32 s47, s47, s57
    v_lshrrev_b32 v15, 5, v0
    v_lshlrev_b32 v15, 9, v15
    v_lshl_add_u32 v15, v46, 5, v15
    v_bfe_u32 v11, v0, 4, 1
    v_lshl_add_u32 v15, v11, 4, v15
    s_waitcnt vmcnt(9)
    v_add_u32 v18, 0x9e3779b9, v18
    v_xor_b32 v19, 0x7f4a7c15, v19
    v_and_b32 v10, 0xff, v18
    v_perm_b32 v48, v24, v24, s44
    v_perm_b32 v49, v24, v24, s45
    v_perm_b32 v50, v25, v25, s44
    v_perm_b32 v51, v25, v25, s45
    v_perm_b32 v52, v26, v26, s44
    v_perm_b32 v53, v26, v26, s45
    v_perm_b32 v54, v27, v27, s44
    v_perm_b32 v55, v27, v27, s45
    v_and_b32 v28, v48, v20
    v_and_b32 v29, v48, v21
    v_and_b32 v30, v48, v22
    v_and_b32 v31, v48, v23
    s_waitcnt vmcnt(8)
    s_nop 0
    v_mfma_f32_16x16x32_bf16 v[36:39], v[28:31], a[224:227], 0
    v_and_b32 v32, v49, v20
    v_and_b32 v33, v49, v21
    v_and_b32 v34, v49, v22
    v_and_b32 v35, v49, v23
    buffer_load_dwordx4 v[84:87], v1, s[8:11], s3 offen offset:1024 nt
    buffer_load_dwordx4 v[88:91], v1, s[8:11], s3 offen offset:2048 nt
    buffer_load_dwordx4 v[92:95], v1, s[8:11], s3 offen offset:3072 nt
    s_mov_b32 s3, 32768
    buffer_load_dwordx4 v[96:99], v1, s[8:11], s3 offen offset:0 nt
    buffer_load_dwordx4 v[100:103], v1, s[8:11], s3 offen offset:1024 nt
    buffer_load_dwordx4 v[104:107], v1, s[8:11], s3 offen offset:2048 nt
    buffer_load_dwordx4 v[108:111], v1, s[8:11], s3 offen offset:3072 nt
    s_waitcnt vmcnt(14)
    v_mfma_f32_16x16x32_bf16 v[36:39], v[32:35], a[228:231], v[36:39]
    v_and_b32 v28, v50, v20
    v_and_b32 v29, v50, v21
    v_and_b32 v30, v50, v22
    v_and_b32 v31, v50, v23
    s_mov_b32 s3, 49152
    buffer_load_dwordx4 v[112:115], v1, s[8:11], s3 offen offset:0 nt
    s_waitcnt vmcnt(14)
    v_mfma_f32_16x16x32_bf16 v[36:39], v[28:31], a[232:235], v[36:39]
    v_and_b32 v32, v51, v20
    v_and_b32 v33, v51, v21
    v_and_b32 v34, v51, v22
    v_and_b32 v35, v51, v23
    buffer_load_dwordx4 v[116:119], v1, s[8:11], s3 offen offset:1024 nt
    s_waitcnt vmcnt(14)
    v_mfma_f32_16x16x32_bf16 v[36:39], v[32:35], a[236:239], v[36:39]
    v_and_b32 v28, v52, v20
    v_and_b32 v29, v52, v21
    v_and_b32 v30, v52, v22
    v_and_b32 v31, v52, v23
    buffer_load_dwordx4 v[120:123], v1, s[8:11], s3 offen offset:2048 nt
    s_waitcnt vmcnt(14)
    v_mfma_f32_16x16x32_bf16 v[36:39], v[28:31], a[240:243], v[36:39]
    v_and_b32 v32, v53, v20
    v_and_b32 v33, v53, v21
    v_and_b32 v34, v53, v22
    v_and_b32 v35, v53, v23
    buffer_load_dwordx4 v[124:127], v1, s[8:11], s3 offen offset:3072 nt
    s_waitcnt vmcnt(14)
    v_mfma_f32_16x16x32_bf16 v[36:39], v[32:35], a[244:247], v[36:39]
    v_and_b32 v28, v54, v20
    v_and_b32 v29, v54, v21
    v_and_b32 v30, v54, v22
    v_and_b32 v31, v54, v23
    s_mov_b32 s3, 65536
    buffer_load_dwordx4 v[128:131], v1, s[8:11], s3 offen offset:0 nt
    s_waitcnt vmcnt(14)
    v_mfma_f32_16x16x32_bf16 v[36:39], v[28:31], a[248:251], v[36:39]
    v_and_b32 v32, v55, v20
    v_and_b32 v33, v55, v21
    v_and_b32 v34, v55, v22
    v_and_b32 v35, v55, v23
    buffer_load_dwordx4 v[132:135], v1, s[8:11], s3 offen offset:1024 nt
    s_waitcnt vmcnt(14)
    v_mfma_f32_16x16x32_bf16 v[36:39], v[32:35], a[252:255], v[36:39]
    buffer_load_dwordx4 v[136:139], v1, s[8:11], s3 offen offset:2048 nt
    s_and_b32 s57, s52, 1
    s_lshl_b32 s57, s57, 20
    s_lshr_b32 s58, s52, 1
    s_lshl_b32 s58, s58, 10
    s_add_u32 s57, s57, s58
    s_lshl_b32 s58, s53, 9
    s_add_u32 s57, s57, s58
    s_add_u32 s57, s57, 65536
    v_lshlrev_b32 v2, 4, v46
    v_lshl_add_u32 v2, v47, 18, v2
    v_add_u32 v2, s57, v2
    ds_write_b128 v15, v[36:39] offset:0
    s_waitcnt lgkmcnt(0)
    s_barrier
    s_and_b32 s57, s47, 0xc0
    s_cbranch_scc1 L_nopub
    ds_read_b128 v[52:55], v15 offset:1024
    ds_read_b128 v[56:59], v15 offset:2048
    ds_read_b128 v[60:63], v15 offset:3072
    s_waitcnt lgkmcnt(0)
    v_pk_add_f32 v[36:37], v[36:37], v[52:53]
    v_pk_add_f32 v[56:57], v[56:57], v[60:61]
    v_pk_add_f32 v[38:39], v[38:39], v[54:55]
    v_pk_add_f32 v[58:59], v[58:59], v[62:63]
    v_pk_add_f32 v[36:37], v[36:37], v[56:57]
    v_pk_add_f32 v[38:39], v[38:39], v[58:59]
    v_and_or_b32 v36, v36, s48, v10
    v_and_or_b32 v37, v37, s48, v10
    v_and_or_b32 v38, v38, s48, v10
    v_and_or_b32 v39, v39, s48, v10
    buffer_store_dwordx4 v[36:39], v13, s[36:39], 0 offen sc1
L_nopub:
    buffer_load_dwordx4 v[140:143], v1, s[8:11], s3 offen offset:3072 nt
    s_waitcnt vmcnt(14)
    s_mov_b32 s3, 81920
    buffer_load_dwordx4 v[144:147], v1, s[8:11], s3 offen offset:0 nt
    buffer_load_dwordx4 v[148:151], v1, s[8:11], s3 offen offset:1024 nt
    s_waitcnt vmcnt(14)
    buffer_load_dwordx4 v[152:155], v1, s[8:11], s3 offen offset:2048 nt
    buffer_load_dwordx4 v[156:159], v1, s[8:11], s3 offen offset:3072 nt
    s_waitcnt vmcnt(14)
    s_mov_b32 s3, 98304
    buffer_load_dwordx4 v[160:163], v1, s[8:11], s3 offen offset:0 nt
    buffer_load_dwordx4 v[164:167], v1, s[8:11], s3 offen offset:1024 nt
    s_waitcnt vmcnt(14)
    buffer_load_dwordx4 v[168:171], v1, s[8:11], s3 offen offset:2048 nt
    buffer_load_dwordx4 v[172:175], v1, s[8:11], s3 offen offset:3072 nt
    s_waitcnt vmcnt(14)
    s_mov_b32 s3, 114688
    buffer_load_dwordx4 v[176:179], v1, s[8:11], s3 offen offset:0 nt
    buffer_load_dwordx4 v[180:183], v1, s[8:11], s3 offen offset:1024 nt
    s_waitcnt vmcnt(14)
    buffer_load_dwordx4 v[184:187], v1, s[8:11], s3 offen offset:2048 nt
    buffer_load_dwordx4 v[188:191], v1, s[8:11], s3 offen offset:3072 nt
    s_waitcnt vmcnt(14)
    s_mov_b32 s3, 131072
    buffer_load_dwordx4 v[192:195], v1, s[8:11], s3 offen offset:0 nt
    buffer_load_dwordx4 v[196:199], v1, s[8:11], s3 offen offset:1024 nt
    s_waitcnt vmcnt(14)
    buffer_load_dwordx4 v[200:203], v1, s[8:11], s3 offen offset:2048 nt
    buffer_load_dwordx4 v[204:207], v1, s[8:11], s3 offen offset:3072 nt
    s_waitcnt vmcnt(14)
    s_mov_b32 s3, 147456
    buffer_load_dwordx4 v[208:211], v1, s[8:11], s3 offen offset:0 nt
    buffer_load_dwordx4 v[212:215], v1, s[8:11], s3 offen offset:1024 nt
    s_waitcnt vmcnt(14)
    buffer_load_dwordx4 v[216:219], v1, s[8:11], s3 offen offset:2048 nt
    buffer_load_dwordx4 v[220:223], v1, s[8:11], s3 offen offset:3072 nt
    s_waitcnt vmcnt(14)
    s_mov_b32 s3, 163840
    buffer_load_dwordx4 v[224:227], v1, s[8:11], s3 offen offset:0 nt
    buffer_load_dwordx4 v[228:231], v1, s[8:11], s3 offen offset:1024 nt
    s_waitcnt vmcnt(14)
    buffer_load_dwordx4 v[232:235], v1, s[8:11], s3 offen offset:2048 nt
    buffer_load_dwordx4 v[236:239], v1, s[8:11], s3 offen offset:3072 nt
    s_waitcnt vmcnt(14)
    s_mov_b32 s3, 180224
    buffer_load_dwordx4 v[240:243], v1, s[8:11], s3 offen offset:0 nt
    buffer_load_dwordx4 v[48:51], v2, s[36:39], 0 offen offset:0 sc1
    buffer_load_dwordx4 v[52:55], v2, s[36:39], 0 offen offset:256 sc1
    s_waitcnt vmcnt(15)
    buffer_load_dwordx4 v[244:247], v1, s[8:11], s3 offen offset:1024 nt
    s_waitcnt vmcnt(14)
    buffer_load_dwordx4 v[248:251], v1, s[8:11], s3 offen offset:2048 nt
    buffer_load_dwordx4 v[252:255], v1, s[8:11], s3 offen offset:3072 nt
    s_waitcnt vmcnt(14)
    s_mov_b32 s3, 196608
    buffer_load_dwordx4 a[160:163], v1, s[8:11], s3 offen offset:0 nt
    buffer_load_dwordx4 a[164:167], v1, s[8:11], s3 offen offset:1024 nt
    s_waitcnt vmcnt(14)
    buffer_load_dwordx4 a[168:171], v1, s[8:11], s3 offen offset:2048 nt
    buffer_load_dwordx4 a[172:175], v1, s[8:11], s3 offen offset:3072 nt
    s_waitcnt vmcnt(14)
    s_mov_b32 s3, 212992
    buffer_load_dwordx4 a[176:179], v1, s[8:11], s3 offen offset:0 nt
    buffer_load_dwordx4 a[180:183], v1, s[8:11], s3 offen offset:1024 nt
    s_waitcnt vmcnt(14)
    buffer_load_dwordx4 a[184:187], v1, s[8:11], s3 offen offset:2048 nt
    buffer_load_dwordx4 a[188:191], v1, s[8:11], s3 offen offset:3072 nt
    s_waitcnt vmcnt(14)
    s_mov_b32 s3, 229376
    buffer_load_dwordx4 a[192:195], v1, s[8:11], s3 offen offset:0 nt
    buffer_load_dwordx4 a[196:199], v1, s[8:11], s3 offen offset:1024 nt
    s_waitcnt vmcnt(14)
    buffer_load_dwordx4 a[200:203], v1, s[8:11], s3 offen offset:2048 nt
    buffer_load_dwordx4 a[204:207], v1, s[8:11], s3 offen offset:3072 nt
    s_waitcnt vmcnt(15)
    s_mov_b32 s3, 245760
    buffer_load_dwordx4 a[208:211], v1, s[8:11], s3 offen offset:0 nt
    v_xor_b32 v48, v48, v10
    v_xor_b32 v49, v49, v10
    v_xor_b32 v50, v50, v10
    v_xor_b32 v51, v51, v10
    v_xor_b32 v52, v52, v10
    v_xor_b32 v53, v53, v10
    v_xor_b32 v54, v54, v10
    v_xor_b32 v55, v55, v10
    v_or3_b32 v44, v48, v49, v50
    v_or3_b32 v44, v44, v51, v52
    v_or3_b32 v44, v44, v53, v54
    v_or_b32 v44, v44, v55
    v_and_b32 v44, 0xff, v44
    v_cmp_ne_u32 vcc, 0, v44
    s_nop 0
    s_cbranch_vccz L_gq_ok
    s_mov_b32 s61, 1048576
L_gq_spin:
    s_nop 4
    buffer_load_dwordx4 v[48:51], v2, s[36:39], 0 offen offset:0 sc1
    buffer_load_dwordx4 v[52:55], v2, s[36:39], 0 offen offset:256 sc1
    s_waitcnt vmcnt(0)
    v_xor_b32 v48, v48, v10
    v_xor_b32 v49, v49, v10
    v_xor_b32 v50, v50, v10
    v_xor_b32 v51, v51, v10
    v_xor_b32 v52, v52, v10
    v_xor_b32 v53, v53, v10
    v_xor_b32 v54, v54, v10
    v_xor_b32 v55, v55, v10
    v_or3_b32 v44, v48, v49, v50
    v_or3_b32 v44, v44, v51, v52
    v_or3_b32 v44, v44, v53, v54
    v_or_b32 v44, v44, v55
    v_and_b32 v44, 0xff, v44
    v_cmp_ne_u32 vcc, 0, v44
    s_nop 0
    s_cbranch_vccz L_gq_ok
    s_sub_u32 s61, s61, 1
    s_cmp_lg_u32 s61, 0
    s_cbranch_scc1 L_gq_spin
L_gq_ok:
    s_nop 4
    v_permlane32_swap_b32 v48, v52
    v_permlane32_swap_b32 v49, v53
    v_permlane32_swap_b32 v50, v54
    v_permlane32_swap_b32 v51, v55
    v_add_f32 v48, v48, v52
    v_add_f32 v49, v49, v53
    v_add_f32 v50, v50, v54
    v_add_f32 v51, v51, v55
    s_nop 0
    v_permlane16_swap_b32 v48, v50
    v_permlane16_swap_b32 v49, v51
    v_add_f32 v48, v48, v50
    v_add_f32 v49, v49, v51
    v_cvt_pk_bf16_f32 v24, v48, v49
    v_cvt_pk_bf16_f32 v25, v48, v49
    s_nop 1
    v_permlane16_swap_b32 v24, v25
    v_mov_b32 v26, v24
    v_mov_b32 v27, v25
    s_nop 0
    v_permlane32_swap_b32 v24, v26
    v_permlane32_swap_b32 v25, v27
    v_dot2_f32_bf16 v44, v64, v24, 0
    v_dot2_f32_bf16 v45, v68, v24, 0
    v_dot2_f32_bf16 v46, v72, v24, 0
    v_dot2_f32_bf16 v47, v76, v24, 0
    v_dot2c_f32_bf16 v44, v65, v25
    v_dot2c_f32_bf16 v45, v69, v25
    v_dot2c_f32_bf16 v46, v73, v25
    v_dot2c_f32_bf16 v47, v77, v25
    v_dot2c_f32_bf16 v44, v66, v26
    v_dot2c_f32_bf16 v45, v70, v26
    v_dot2c_f32_bf16 v46, v74, v26
    v_dot2c_f32_bf16 v47, v78, v26
    v_dot2c_f32_bf16 v44, v67, v27
    v_dot2c_f32_bf16 v45, v71, v27
    v_dot2c_f32_bf16 v46, v75, v27
    v_dot2c_f32_bf16 v47, v79, v27
    v_add_f32_dpp v44, v44, v44 row_ror:8 row_mask:0xf bank_mask:0x3
    v_add_f32_dpp v45, v45, v45 row_ror:8 row_mask:0xf bank_mask:0x3
    s_nop 0
    v_add_f32_dpp v44, v46, v46 row_ror:8 row_mask:0xf bank_mask:0xc
    v_add_f32_dpp v45, v47, v47 row_ror:8 row_mask:0xf bank_mask:0xc
    s_nop 0
    v_add_f32_dpp v44, v44, v44 row_half_mirror row_mask:0xf bank_mask:0x5
    s_nop 1
    v_add_f32_dpp v44, v45, v45 row_half_mirror row_mask:0xf bank_mask:0xa
    s_nop 1
    v_add_f32_dpp v44, v44, v44 quad_perm:[1,0,3,2] row_mask:0xf bank_mask:0xf
    s_nop 1
    v_add_f32_dpp v48, v44, v44 quad_perm:[2,3,0,1] row_mask:0xf bank_mask:0xf
    v_dot2_f32_bf16 v44, v80, v24, 0
    v_dot2_f32_bf16 v45, v84, v24, 0
    v_dot2_f32_bf16 v46, v88, v24, 0
    v_dot2_f32_bf16 v47, v92, v24, 0
    v_dot2c_f32_bf16 v44, v81, v25
    v_dot2c_f32_bf16 v45, v85, v25
    v_dot2c_f32_bf16 v46, v89, v25
    v_dot2c_f32_bf16 v47, v93, v25
    v_dot2c_f32_bf16 v44, v82, v26
    v_dot2c_f32_bf16 v45, v86, v26
    v_dot2c_f32_bf16 v46, v90, v26
    v_dot2c_f32_bf16 v47, v94, v26
    v_dot2c_f32_bf16 v44, v83, v27
    v_dot2c_f32_bf16 v45, v87, v27
    v_dot2c_f32_bf16 v46, v91, v27
    v_dot2c_f32_bf16 v47, v95, v27
    buffer_load_dword v12, v4, s[36:39], 0 offen sc1
    buffer_load_dword v13, v43, s[36:39], 0 offen sc1
    v_add_f32_dpp v44, v44, v44 row_ror:8 row_mask:0xf bank_mask:0x3
    v_add_f32_dpp v45, v45, v45 row_ror:8 row_mask:0xf bank_mask:0x3
    s_nop 0
    v_add_f32_dpp v44, v46, v46 row_ror:8 row_mask:0xf bank_mask:0xc
    v_add_f32_dpp v45, v47, v47 row_ror:8 row_mask:0xf bank_mask:0xc
    s_nop 0
    v_add_f32_dpp v44, v44, v44 row_half_mirror row_mask:0xf bank_mask:0x5
    s_nop 1
    v_add_f32_dpp v44, v45, v45 row_half_mirror row_mask:0xf bank_mask:0xa
    s_nop 1
    v_add_f32_dpp v44, v44, v44 quad_perm:[1,0,3,2] row_mask:0xf bank_mask:0xf
    s_nop 1
    v_add_f32_dpp v49, v44, v44 quad_perm:[2,3,0,1] row_mask:0xf bank_mask:0xf
    v_dot2_f32_bf16 v44, v96, v24, 0
    v_dot2_f32_bf16 v45, v100, v24, 0
    v_dot2_f32_bf16 v46, v104, v24, 0
    v_dot2_f32_bf16 v47, v108, v24, 0
    v_dot2c_f32_bf16 v44, v97, v25
    v_dot2c_f32_bf16 v45, v101, v25
    v_dot2c_f32_bf16 v46, v105, v25
    v_dot2c_f32_bf16 v47, v109, v25
    v_dot2c_f32_bf16 v44, v98, v26
    v_dot2c_f32_bf16 v45, v102, v26
    v_dot2c_f32_bf16 v46, v106, v26
    v_dot2c_f32_bf16 v47, v110, v26
    v_dot2c_f32_bf16 v44, v99, v27
    v_dot2c_f32_bf16 v45, v103, v27
    v_dot2c_f32_bf16 v46, v107, v27
    v_dot2c_f32_bf16 v47, v111, v27
    v_add_f32_dpp v44, v44, v44 row_ror:8 row_mask:0xf bank_mask:0x3
    v_add_f32_dpp v45, v45, v45 row_ror:8 row_mask:0xf bank_mask:0x3
    s_nop 0
    v_add_f32_dpp v44, v46, v46 row_ror:8 row_mask:0xf bank_mask:0xc
    v_add_f32_dpp v45, v47, v47 row_ror:8 row_mask:0xf bank_mask:0xc
    s_nop 0
    v_add_f32_dpp v44, v44, v44 row_half_mirror row_mask:0xf bank_mask:0x5
    s_nop 1
    v_add_f32_dpp v44, v45, v45 row_half_mirror row_mask:0xf bank_mask:0xa
    s_nop 1
    v_add_f32_dpp v44, v44, v44 quad_perm:[1,0,3,2] row_mask:0xf bank_mask:0xf
    s_nop 1
    v_add_f32_dpp v50, v44, v44 quad_perm:[2,3,0,1] row_mask:0xf bank_mask:0xf
    v_dot2_f32_bf16 v44, v112, v24, 0
    v_dot2_f32_bf16 v45, v116, v24, 0
    v_dot2_f32_bf16 v46, v120, v24, 0
    v_dot2_f32_bf16 v47, v124, v24, 0
    v_dot2c_f32_bf16 v44, v113, v25
    v_dot2c_f32_bf16 v45, v117, v25
    v_dot2c_f32_bf16 v46, v121, v25
    v_dot2c_f32_bf16 v47, v125, v25
    v_dot2c_f32_bf16 v44, v114, v26
    v_dot2c_f32_bf16 v45, v118, v26
    v_dot2c_f32_bf16 v46, v122, v26
    v_dot2c_f32_bf16 v47, v126, v26
    v_dot2c_f32_bf16 v44, v115, v27
    v_dot2c_f32_bf16 v45, v119, v27
    v_dot2c_f32_bf16 v46, v123, v27
    v_dot2c_f32_bf16 v47, v127, v27
    buffer_load_dwordx4 a[212:215], v1, s[8:11], s3 offen offset:1024 nt
    v_add_f32_dpp v44, v44, v44 row_ror:8 row_mask:0xf bank_mask:0x3
    v_add_f32_dpp v45, v45, v45 row_ror:8 row_mask:0xf bank_mask:0x3
    s_nop 0
    v_add_f32_dpp v44, v46, v46 row_ror:8 row_mask:0xf bank_mask:0xc
    v_add_f32_dpp v45, v47, v47 row_ror:8 row_mask:0xf bank_mask:0xc
    s_nop 0
    v_add_f32_dpp v44, v44, v44 row_half_mirror row_mask:0xf bank_mask:0x5
    s_nop 1
    v_add_f32_dpp v44, v45, v45 row_half_mirror row_mask:0xf bank_mask:0xa
    s_nop 1
    v_add_f32_dpp v44, v44, v44 quad_perm:[1,0,3,2] row_mask:0xf bank_mask:0xf
    s_nop 1
    v_add_f32_dpp v51, v44, v44 quad_perm:[2,3,0,1] row_mask:0xf bank_mask:0xf
    v_dot2_f32_bf16 v44, v128, v24, 0
    v_dot2_f32_bf16 v45, v132, v24, 0
    v_dot2_f32_bf16 v46, v136, v24, 0
    v_dot2_f32_bf16 v47, v140, v24, 0
    v_dot2c_f32_bf16 v44, v129, v25
    v_dot2c_f32_bf16 v45, v133, v25
    v_dot2c_f32_bf16 v46, v137, v25
    v_dot2c_f32_bf16 v47, v141, v25
    v_dot2c_f32_bf16 v44, v130, v26
    v_dot2c_f32_bf16 v45, v134, v26
    v_dot2c_f32_bf16 v46, v138, v26
    v_dot2c_f32_bf16 v47, v142, v26
    v_dot2c_f32_bf16 v44, v131, v27
    v_dot2c_f32_bf16 v45, v135, v27
    v_dot2c_f32_bf16 v46, v139, v27
    v_dot2c_f32_bf16 v47, v143, v27
    v_add_f32_dpp v44, v44, v44 row_ror:8 row_mask:0xf bank_mask:0x3
    v_add_f32_dpp v45, v45, v45 row_ror:8 row_mask:0xf bank_mask:0x3
    s_nop 0
    v_add_f32_dpp v44, v46, v46 row_ror:8 row_mask:0xf bank_mask:0xc
    v_add_f32_dpp v45, v47, v47 row_ror:8 row_mask:0xf bank_mask:0xc
    s_nop 0
    v_add_f32_dpp v44, v44, v44 row_half_mirror row_mask:0xf bank_mask:0x5
    s_nop 1
    v_add_f32_dpp v44, v45, v45 row_half_mirror row_mask:0xf bank_mask:0xa
    s_nop 1
    v_add_f32_dpp v44, v44, v44 quad_perm:[1,0,3,2] row_mask:0xf bank_mask:0xf
    s_nop 1
    v_add_f32_dpp v52, v44, v44 quad_perm:[2,3,0,1] row_mask:0xf bank_mask:0xf
    v_dot2_f32_bf16 v44, v144, v24, 0
    v_dot2_f32_bf16 v45, v148, v24, 0
    v_dot2_f32_bf16 v46, v152, v24, 0
    v_dot2_f32_bf16 v47, v156, v24, 0
    v_dot2c_f32_bf16 v44, v145, v25
    v_dot2c_f32_bf16 v45, v149, v25
    v_dot2c_f32_bf16 v46, v153, v25
    v_dot2c_f32_bf16 v47, v157, v25
    v_dot2c_f32_bf16 v44, v146, v26
    v_dot2c_f32_bf16 v45, v150, v26
    v_dot2c_f32_bf16 v46, v154, v26
    v_dot2c_f32_bf16 v47, v158, v26
    v_dot2c_f32_bf16 v44, v147, v27
    v_dot2c_f32_bf16 v45, v151, v27
    v_dot2c_f32_bf16 v46, v155, v27
    v_dot2c_f32_bf16 v47, v159, v27
    buffer_load_dwordx4 a[216:219], v1, s[8:11], s3 offen offset:2048 nt
    v_add_f32_dpp v44, v44, v44 row_ror:8 row_mask:0xf bank_mask:0x3
    v_add_f32_dpp v45, v45, v45 row_ror:8 row_mask:0xf bank_mask:0x3
    s_nop 0
    v_add_f32_dpp v44, v46, v46 row_ror:8 row_mask:0xf bank_mask:0xc
    v_add_f32_dpp v45, v47, v47 row_ror:8 row_mask:0xf bank_mask:0xc
    s_nop 0
    v_add_f32_dpp v44, v44, v44 row_half_mirror row_mask:0xf bank_mask:0x5
    s_nop 1
    v_add_f32_dpp v44, v45, v45 row_half_mirror row_mask:0xf bank_mask:0xa
    s_nop 1
    v_add_f32_dpp v44, v44, v44 quad_perm:[1,0,3,2] row_mask:0xf bank_mask:0xf
    s_nop 1
    v_add_f32_dpp v53, v44, v44 quad_perm:[2,3,0,1] row_mask:0xf bank_mask:0xf
    v_dot2_f32_bf16 v44, v160, v24, 0
    v_dot2_f32_bf16 v45, v164, v24, 0
    v_dot2_f32_bf16 v46, v168, v24, 0
    v_dot2_f32_bf16 v47, v172, v24, 0
    v_dot2c_f32_bf16 v44, v161, v25
    v_dot2c_f32_bf16 v45, v165, v25
    v_dot2c_f32_bf16 v46, v169, v25
    v_dot2c_f32_bf16 v47, v173, v25
    v_dot2c_f32_bf16 v44, v162, v26
    v_dot2c_f32_bf16 v45, v166, v26
    v_dot2c_f32_bf16 v46, v170, v26
    v_dot2c_f32_bf16 v47, v174, v26
    v_dot2c_f32_bf16 v44, v163, v27
    v_dot2c_f32_bf16 v45, v167, v27
    v_dot2c_f32_bf16 v46, v171, v27
    v_dot2c_f32_bf16 v47, v175, v27
    v_add_f32_dpp v44, v44, v44 row_ror:8 row_mask:0xf bank_mask:0x3
    v_add_f32_dpp v45, v45, v45 row_ror:8 row_mask:0xf bank_mask:0x3
    s_nop 0
    v_add_f32_dpp v44, v46, v46 row_ror:8 row_mask:0xf bank_mask:0xc
    v_add_f32_dpp v45, v47, v47 row_ror:8 row_mask:0xf bank_mask:0xc
    s_nop 0
    v_add_f32_dpp v44, v44, v44 row_half_mirror row_mask:0xf bank_mask:0x5
    s_nop 1
    v_add_f32_dpp v44, v45, v45 row_half_mirror row_mask:0xf bank_mask:0xa
    s_nop 1
    v_add_f32_dpp v44, v44, v44 quad_perm:[1,0,3,2] row_mask:0xf bank_mask:0xf
    s_nop 1
    v_add_f32_dpp v54, v44, v44 quad_perm:[2,3,0,1] row_mask:0xf bank_mask:0xf
    v_dot2_f32_bf16 v44, v176, v24, 0
    v_dot2_f32_bf16 v45, v180, v24, 0
    v_dot2_f32_bf16 v46, v184, v24, 0
    v_dot2_f32_bf16 v47, v188, v24, 0
    v_dot2c_f32_bf16 v44, v177, v25
    v_dot2c_f32_bf16 v45, v181, v25
    v_dot2c_f32_bf16 v46, v185, v25
    v_dot2c_f32_bf16 v47, v189, v25
    v_dot2c_f32_bf16 v44, v178, v26
    v_dot2c_f32_bf16 v45, v182, v26
    v_dot2c_f32_bf16 v46, v186, v26
    v_dot2c_f32_bf16 v47, v190, v26
    v_dot2c_f32_bf16 v44, v179, v27
    v_dot2c_f32_bf16 v45, v183, v27
    v_dot2c_f32_bf16 v46, v187, v27
    v_dot2c_f32_bf16 v47, v191, v27
    buffer_load_dwordx4 a[220:223], v1, s[8:11], s3 offen offset:3072 nt
    v_add_f32_dpp v44, v44, v44 row_ror:8 row_mask:0xf bank_mask:0x3
    v_add_f32_dpp v45, v45, v45 row_ror:8 row_mask:0xf bank_mask:0x3
    s_nop 0
    v_add_f32_dpp v44, v46, v46 row_ror:8 row_mask:0xf bank_mask:0xc
    v_add_f32_dpp v45, v47, v47 row_ror:8 row_mask:0xf bank_mask:0xc
    s_nop 0
    v_add_f32_dpp v44, v44, v44 row_half_mirror row_mask:0xf bank_mask:0x5
    s_nop 1
    v_add_f32_dpp v44, v45, v45 row_half_mirror row_mask:0xf bank_mask:0xa
    s_nop 1
    v_add_f32_dpp v44, v44, v44 quad_perm:[1,0,3,2] row_mask:0xf bank_mask:0xf
    s_nop 1
    v_add_f32_dpp v55, v44, v44 quad_perm:[2,3,0,1] row_mask:0xf bank_mask:0xf
    v_dot2_f32_bf16 v44, v192, v24, 0
    v_dot2_f32_bf16 v45, v196, v24, 0
    v_dot2_f32_bf16 v46, v200, v24, 0
    v_dot2_f32_bf16 v47, v204, v24, 0
    v_dot2c_f32_bf16 v44, v193, v25
    v_dot2c_f32_bf16 v45, v197, v25
    v_dot2c_f32_bf16 v46, v201, v25
    v_dot2c_f32_bf16 v47, v205, v25
    v_dot2c_f32_bf16 v44, v194, v26
    v_dot2c_f32_bf16 v45, v198, v26
    v_dot2c_f32_bf16 v46, v202, v26
    v_dot2c_f32_bf16 v47, v206, v26
    v_dot2c_f32_bf16 v44, v195, v27
    v_dot2c_f32_bf16 v45, v199, v27
    v_dot2c_f32_bf16 v46, v203, v27
    v_dot2c_f32_bf16 v47, v207, v27
    v_add_f32_dpp v44, v44, v44 row_ror:8 row_mask:0xf bank_mask:0x3
    v_add_f32_dpp v45, v45, v45 row_ror:8 row_mask:0xf bank_mask:0x3
    s_nop 0
    v_add_f32_dpp v44, v46, v46 row_ror:8 row_mask:0xf bank_mask:0xc
    v_add_f32_dpp v45, v47, v47 row_ror:8 row_mask:0xf bank_mask:0xc
    s_nop 0
    v_add_f32_dpp v44, v44, v44 row_half_mirror row_mask:0xf bank_mask:0x5
    s_nop 1
    v_add_f32_dpp v44, v45, v45 row_half_mirror row_mask:0xf bank_mask:0xa
    s_nop 1
    v_add_f32_dpp v44, v44, v44 quad_perm:[1,0,3,2] row_mask:0xf bank_mask:0xf
    s_nop 1
    v_add_f32_dpp v56, v44, v44 quad_perm:[2,3,0,1] row_mask:0xf bank_mask:0xf
    v_dot2_f32_bf16 v44, v208, v24, 0
    v_dot2_f32_bf16 v45, v212, v24, 0
    v_dot2_f32_bf16 v46, v216, v24, 0
    v_dot2_f32_bf16 v47, v220, v24, 0
    v_dot2c_f32_bf16 v44, v209, v25
    v_dot2c_f32_bf16 v45, v213, v25
    v_dot2c_f32_bf16 v46, v217, v25
    v_dot2c_f32_bf16 v47, v221, v25
    v_dot2c_f32_bf16 v44, v210, v26
    v_dot2c_f32_bf16 v45, v214, v26
    v_dot2c_f32_bf16 v46, v218, v26
    v_dot2c_f32_bf16 v47, v222, v26
    v_dot2c_f32_bf16 v44, v211, v27
    v_dot2c_f32_bf16 v45, v215, v27
    v_dot2c_f32_bf16 v46, v219, v27
    v_dot2c_f32_bf16 v47, v223, v27
    s_mov_b32 s3, 0
    buffer_load_dwordx4 a[0:3], v1, s[12:15], s3 offen offset:0 nt
    v_add_f32_dpp v44, v44, v44 row_ror:8 row_mask:0xf bank_mask:0x3
    v_add_f32_dpp v45, v45, v45 row_ror:8 row_mask:0xf bank_mask:0x3
    s_nop 0
    v_add_f32_dpp v44, v46, v46 row_ror:8 row_mask:0xf bank_mask:0xc
    v_add_f32_dpp v45, v47, v47 row_ror:8 row_mask:0xf bank_mask:0xc
    s_nop 0
    v_add_f32_dpp v44, v44, v44 row_half_mirror row_mask:0xf bank_mask:0x5
    s_nop 1
    v_add_f32_dpp v44, v45, v45 row_half_mirror row_mask:0xf bank_mask:0xa
    s_nop 1
    v_add_f32_dpp v44, v44, v44 quad_perm:[1,0,3,2] row_mask:0xf bank_mask:0xf
    s_nop 1
    v_add_f32_dpp v57, v44, v44 quad_perm:[2,3,0,1] row_mask:0xf bank_mask:0xf
    v_dot2_f32_bf16 v44, v224, v24, 0
    v_dot2_f32_bf16 v45, v228, v24, 0
    v_dot2_f32_bf16 v46, v232, v24, 0
    v_dot2_f32_bf16 v47, v236, v24, 0
    v_dot2c_f32_bf16 v44, v225, v25
    v_dot2c_f32_bf16 v45, v229, v25
    v_dot2c_f32_bf16 v46, v233, v25
    v_dot2c_f32_bf16 v47, v237, v25
    v_dot2c_f32_bf16 v44, v226, v26
    v_dot2c_f32_bf16 v45, v230, v26
    v_dot2c_f32_bf16 v46, v234, v26
    v_dot2c_f32_bf16 v47, v238, v26
    v_dot2c_f32_bf16 v44, v227, v27
    v_dot2c_f32_bf16 v45, v231, v27
    v_dot2c_f32_bf16 v46, v235, v27
    v_dot2c_f32_bf16 v47, v239, v27
    v_add_f32_dpp v44, v44, v44 row_ror:8 row_mask:0xf bank_mask:0x3
    v_add_f32_dpp v45, v45, v45 row_ror:8 row_mask:0xf bank_mask:0x3
    s_nop 0
    v_add_f32_dpp v44, v46, v46 row_ror:8 row_mask:0xf bank_mask:0xc
    v_add_f32_dpp v45, v47, v47 row_ror:8 row_mask:0xf bank_mask:0xc
    s_nop 0
    v_add_f32_dpp v44, v44, v44 row_half_mirror row_mask:0xf bank_mask:0x5
    s_nop 1
    v_add_f32_dpp v44, v45, v45 row_half_mirror row_mask:0xf bank_mask:0xa
    s_nop 1
    v_add_f32_dpp v44, v44, v44 quad_perm:[1,0,3,2] row_mask:0xf bank_mask:0xf
    s_nop 1
    v_add_f32_dpp v58, v44, v44 quad_perm:[2,3,0,1] row_mask:0xf bank_mask:0xf
    s_waitcnt vmcnt(19)
    v_dot2_f32_bf16 v44, v240, v24, 0
    v_dot2_f32_bf16 v45, v244, v24, 0
    v_dot2_f32_bf16 v46, v248, v24, 0
    v_dot2_f32_bf16 v47, v252, v24, 0
    v_dot2c_f32_bf16 v44, v241, v25
    v_dot2c_f32_bf16 v45, v245, v25
    v_dot2c_f32_bf16 v46, v249, v25
    v_dot2c_f32_bf16 v47, v253, v25
    v_dot2c_f32_bf16 v44, v242, v26
    v_dot2c_f32_bf16 v45, v246, v26
    v_dot2c_f32_bf16 v46, v250, v26
    v_dot2c_f32_bf16 v47, v254, v26
    v_dot2c_f32_bf16 v44, v243, v27
    v_dot2c_f32_bf16 v45, v247, v27
    v_dot2c_f32_bf16 v46, v251, v27
    v_dot2c_f32_bf16 v47, v255, v27
    v_add_f32_dpp v44, v44, v44 row_ror:8 row_mask:0xf bank_mask:0x3
    v_add_f32_dpp v45, v45, v45 row_ror:8 row_mask:0xf bank_mask:0x3
    s_nop 0
    v_add_f32_dpp v44, v46, v46 row_ror:8 row_mask:0xf bank_mask:0xc
    v_add_f32_dpp v45, v47, v47 row_ror:8 row_mask:0xf bank_mask:0xc
    s_nop 0
    v_add_f32_dpp v44, v44, v44 row_half_mirror row_mask:0xf bank_mask:0x5
    s_nop 1
    v_add_f32_dpp v44, v45, v45 row_half_mirror row_mask:0xf bank_mask:0xa
    s_nop 1
    v_add_f32_dpp v44, v44, v44 quad_perm:[1,0,3,2] row_mask:0xf bank_mask:0xf
    s_nop 1
    v_add_f32_dpp v59, v44, v44 quad_perm:[2,3,0,1] row_mask:0xf bank_mask:0xf
    s_waitcnt vmcnt(15)
    v_accvgpr_read_b32 v112, a160
    v_accvgpr_read_b32 v113, a161
    v_accvgpr_read_b32 v114, a162
    v_accvgpr_read_b32 v115, a163
    v_accvgpr_read_b32 v116, a164
    v_accvgpr_read_b32 v117, a165
    v_accvgpr_read_b32 v118, a166
    v_accvgpr_read_b32 v119, a167
    v_accvgpr_read_b32 v120, a168
    v_accvgpr_read_b32 v121, a169
    v_accvgpr_read_b32 v122, a170
    v_accvgpr_read_b32 v123, a171
    v_accvgpr_read_b32 v124, a172
    v_accvgpr_read_b32 v125, a173
    v_accvgpr_read_b32 v126, a174
    v_accvgpr_read_b32 v127, a175
    v_dot2_f32_bf16 v44, v112, v24, 0
    v_dot2_f32_bf16 v45, v116, v24, 0
    v_dot2_f32_bf16 v46, v120, v24, 0
    v_dot2_f32_bf16 v47, v124, v24, 0
    v_dot2c_f32_bf16 v44, v113, v25
    v_dot2c_f32_bf16 v45, v117, v25
    v_dot2c_f32_bf16 v46, v121, v25
    v_dot2c_f32_bf16 v47, v125, v25
    v_dot2c_f32_bf16 v44, v114, v26
    v_dot2c_f32_bf16 v45, v118, v26
    v_dot2c_f32_bf16 v46, v122, v26
    v_dot2c_f32_bf16 v47, v126, v26
    v_dot2c_f32_bf16 v44, v115, v27
    v_dot2c_f32_bf16 v45, v119, v27
    v_dot2c_f32_bf16 v46, v123, v27
    v_dot2c_f32_bf16 v47, v127, v27
    buffer_load_dwordx4 a[4:7], v1, s[12:15], s3 offen offset:1024 nt
    v_add_f32_dpp v44, v44, v44 row_ror:8 row_mask:0xf bank_mask:0x3
    v_add_f32_dpp v45, v45, v45 row_ror:8 row_mask:0xf bank_mask:0x3
    s_nop 0
    v_add_f32_dpp v44, v46, v46 row_ror:8 row_mask:0xf bank_mask:0xc
    v_add_f32_dpp v45, v47, v47 row_ror:8 row_mask:0xf bank_mask:0xc
    s_nop 0
    v_add_f32_dpp v44, v44, v44 row_half_mirror row_mask:0xf bank_mask:0x5
    s_nop 1
    v_add_f32_dpp v44, v45, v45 row_half_mirror row_mask:0xf bank_mask:0xa
    s_nop 1
    v_add_f32_dpp v44, v44, v44 quad_perm:[1,0,3,2] row_mask:0xf bank_mask:0xf
    s_nop 1
    v_add_f32_dpp v60, v44, v44 quad_perm:[2,3,0,1] row_mask:0xf bank_mask:0xf
    s_waitcnt vmcnt(12)
    v_accvgpr_read_b32 v112, a176
    v_accvgpr_read_b32 v113, a177
    v_accvgpr_read_b32 v114, a178
    v_accvgpr_read_b32 v115, a179
    v_accvgpr_read_b32 v116, a180
    v_accvgpr_read_b32 v117, a181
    v_accvgpr_read_b32 v118, a182
    v_accvgpr_read_b32 v119, a183
    v_accvgpr_read_b32 v120, a184
    v_accvgpr_read_b32 v121, a185
    v_accvgpr_read_b32 v122, a186
    v_accvgpr_read_b32 v123, a187
    v_accvgpr_read_b32 v124, a188
    v_accvgpr_read_b32 v125, a189
    v_accvgpr_read_b32 v126, a190
    v_accvgpr_read_b32 v127, a191
    v_dot2_f32_bf16 v44, v112, v24, 0
    v_dot2_f32_bf16 v45, v116, v24, 0
    v_dot2_f32_bf16 v46, v120, v24, 0
    v_dot2_f32_bf16 v47, v124, v24, 0
    v_dot2c_f32_bf16 v44, v113, v25
    v_dot2c_f32_bf16 v45, v117, v25
    v_dot2c_f32_bf16 v46, v121, v25
    v_dot2c_f32_bf16 v47, v125, v25
    v_dot2c_f32_bf16 v44, v114, v26
    v_dot2c_f32_bf16 v45, v118, v26
    v_dot2c_f32_bf16 v46, v122, v26
    v_dot2c_f32_bf16 v47, v126, v26
    v_dot2c_f32_bf16 v44, v115, v27
    v_dot2c_f32_bf16 v45, v119, v27
    v_dot2c_f32_bf16 v46, v123, v27
    v_dot2c_f32_bf16 v47, v127, v27
    buffer_load_dwordx4 a[8:11], v1, s[12:15], s3 offen offset:2048 nt
    s_mov_b32 s59, 0
    buffer_load_dwordx4 v[128:131], v3, s[20:23], s59 offen
    buffer_load_dwordx4 a[12:15], v1, s[12:15], s3 offen offset:3072 nt
    s_mov_b32 s59, 4096
    buffer_load_dwordx4 v[132:135], v3, s[20:23], s59 offen
    v_add_f32_dpp v44, v44, v44 row_ror:8 row_mask:0xf bank_mask:0x3
    v_add_f32_dpp v45, v45, v45 row_ror:8 row_mask:0xf bank_mask:0x3
    s_nop 0
    v_add_f32_dpp v44, v46, v46 row_ror:8 row_mask:0xf bank_mask:0xc
    v_add_f32_dpp v45, v47, v47 row_ror:8 row_mask:0xf bank_mask:0xc
    s_nop 0
    v_add_f32_dpp v44, v44, v44 row_half_mirror row_mask:0xf bank_mask:0x5
    s_nop 1
    v_add_f32_dpp v44, v45, v45 row_half_mirror row_mask:0xf bank_mask:0xa
    s_nop 1
    v_add_f32_dpp v44, v44, v44 quad_perm:[1,0,3,2] row_mask:0xf bank_mask:0xf
    s_nop 1
    v_add_f32_dpp v61, v44, v44 quad_perm:[2,3,0,1] row_mask:0xf bank_mask:0xf
    s_waitcnt vmcnt(12)
    v_accvgpr_read_b32 v112, a192
    v_accvgpr_read_b32 v113, a193
    v_accvgpr_read_b32 v114, a194
    v_accvgpr_read_b32 v115, a195
    v_accvgpr_read_b32 v116, a196
    v_accvgpr_read_b32 v117, a197
    v_accvgpr_read_b32 v118, a198
    v_accvgpr_read_b32 v119, a199
    v_accvgpr_read_b32 v120, a200
    v_accvgpr_read_b32 v121, a201
    v_accvgpr_read_b32 v122, a202
    v_accvgpr_read_b32 v123, a203
    v_accvgpr_read_b32 v124, a204
    v_accvgpr_read_b32 v125, a205
    v_accvgpr_read_b32 v126, a206
    v_accvgpr_read_b32 v127, a207
    v_dot2_f32_bf16 v44, v112, v24, 0
    v_dot2_f32_bf16 v45, v116, v24, 0
    v_dot2_f32_bf16 v46, v120, v24, 0
    v_dot2_f32_bf16 v47, v124, v24, 0
    v_dot2c_f32_bf16 v44, v113, v25
    v_dot2c_f32_bf16 v45, v117, v25
    v_dot2c_f32_bf16 v46, v121, v25
    v_dot2c_f32_bf16 v47, v125, v25
    v_dot2c_f32_bf16 v44, v114, v26
    v_dot2c_f32_bf16 v45, v118, v26
    v_dot2c_f32_bf16 v46, v122, v26
    v_dot2c_f32_bf16 v47, v126, v26
    v_dot2c_f32_bf16 v44, v115, v27
    v_dot2c_f32_bf16 v45, v119, v27
    v_dot2c_f32_bf16 v46, v123, v27
    v_dot2c_f32_bf16 v47, v127, v27
    s_mov_b32 s3, 16384
    buffer_load_dwordx4 a[16:19], v1, s[12:15], s3 offen offset:0 nt
    v_and_b32 v104, 63, v0
    v_lshlrev_b32 v104, 4, v104
    s_lshl_b32 s59, s53, 10
    buffer_load_dwordx4 v[88:91], v104, s[4:7], s59 offen
    buffer_load_dwordx4 v[92:95], v104, s[28:31], 0 offen
    buffer_load_dwordx4 v[64:67], v5, s[24:27], 0 offen offset:0
    v_add_f32_dpp v44, v44, v44 row_ror:8 row_mask:0xf bank_mask:0x3
    v_add_f32_dpp v45, v45, v45 row_ror:8 row_mask:0xf bank_mask:0x3
    s_nop 0
    v_add_f32_dpp v44, v46, v46 row_ror:8 row_mask:0xf bank_mask:0xc
    v_add_f32_dpp v45, v47, v47 row_ror:8 row_mask:0xf bank_mask:0xc
    s_nop 0
    v_add_f32_dpp v44, v44, v44 row_half_mirror row_mask:0xf bank_mask:0x5
    s_nop 1
    v_add_f32_dpp v44, v45, v45 row_half_mirror row_mask:0xf bank_mask:0xa
    s_nop 1
    v_add_f32_dpp v44, v44, v44 quad_perm:[1,0,3,2] row_mask:0xf bank_mask:0xf
    s_nop 1
    v_add_f32_dpp v62, v44, v44 quad_perm:[2,3,0,1] row_mask:0xf bank_mask:0xf
    s_waitcnt vmcnt(10)
    v_accvgpr_read_b32 v112, a208
    v_accvgpr_read_b32 v113, a209
    v_accvgpr_read_b32 v114, a210
    v_accvgpr_read_b32 v115, a211
    v_accvgpr_read_b32 v116, a212
    v_accvgpr_read_b32 v117, a213
    v_accvgpr_read_b32 v118, a214
    v_accvgpr_read_b32 v119, a215
    v_accvgpr_read_b32 v120, a216
    v_accvgpr_read_b32 v121, a217
    v_accvgpr_read_b32 v122, a218
    v_accvgpr_read_b32 v123, a219
    v_accvgpr_read_b32 v124, a220
    v_accvgpr_read_b32 v125, a221
    v_accvgpr_read_b32 v126, a222
    v_accvgpr_read_b32 v127, a223
    v_dot2_f32_bf16 v44, v112, v24, 0
    v_dot2_f32_bf16 v45, v116, v24, 0
    v_dot2_f32_bf16 v46, v120, v24, 0
    v_dot2_f32_bf16 v47, v124, v24, 0
    v_dot2c_f32_bf16 v44, v113, v25
    v_dot2c_f32_bf16 v45, v117, v25
    v_dot2c_f32_bf16 v46, v121, v25
    v_dot2c_f32_bf16 v47, v125, v25
    v_dot2c_f32_bf16 v44, v114, v26
    v_dot2c_f32_bf16 v45, v118, v26
    v_dot2c_f32_bf16 v46, v122, v26
    v_dot2c_f32_bf16 v47, v126, v26
    v_dot2c_f32_bf16 v44, v115, v27
    v_dot2c_f32_bf16 v45, v119, v27
    v_dot2c_f32_bf16 v46, v123, v27
    v_dot2c_f32_bf16 v47, v127, v27
    buffer_load_dwordx4 v[68:71], v5, s[24:27], 0 offen offset:1024
    buffer_load_dwordx4 v[72:75], v5, s[24:27], 0 offen offset:2048
    buffer_load_dwordx4 v[76:79], v5, s[24:27], 0 offen offset:3072
    buffer_load_dwordx4 a[20:23], v1, s[12:15], s3 offen offset:1024 nt
    s_mov_b32 s59, 8192
    buffer_load_dwordx4 v[136:139], v3, s[20:23], s59 offen
    buffer_load_dwordx4 a[24:27], v1, s[12:15], s3 offen offset:2048 nt
    v_add_f32_dpp v44, v44, v44 row_ror:8 row_mask:0xf bank_mask:0x3
    v_add_f32_dpp v45, v45, v45 row_ror:8 row_mask:0xf bank_mask:0x3
    s_nop 0
    v_add_f32_dpp v44, v46, v46 row_ror:8 row_mask:0xf bank_mask:0xc
    v_add_f32_dpp v45, v47, v47 row_ror:8 row_mask:0xf bank_mask:0xc
    s_nop 0
    v_add_f32_dpp v44, v44, v44 row_half_mirror row_mask:0xf bank_mask:0x5
    s_nop 1
    v_add_f32_dpp v44, v45, v45 row_half_mirror row_mask:0xf bank_mask:0xa
    s_nop 1
    v_add_f32_dpp v44, v44, v44 quad_perm:[1,0,3,2] row_mask:0xf bank_mask:0xf
    s_nop 1
    v_add_f32_dpp v63, v44, v44 quad_perm:[2,3,0,1] row_mask:0xf bank_mask:0xf
    v_cvt_pk_bf16_f32 v49, v48, v49
    v_cvt_pk_bf16_f32 v51, v50, v51
    v_cvt_pk_bf16_f32 v53, v52, v53
    v_cvt_pk_bf16_f32 v55, v54, v55
    v_cvt_pk_bf16_f32 v57, v56, v57
    v_cvt_pk_bf16_f32 v59, v58, v59
    v_cvt_pk_bf16_f32 v61, v60, v61
    v_cvt_pk_bf16_f32 v63, v62, v63
    v_lshlrev_b32 v48, 16, v49
    v_and_b32 v49, 0xffff0000, v49
    v_lshlrev_b32 v50, 16, v51
    v_and_b32 v51, 0xffff0000, v51
    v_lshlrev_b32 v52, 16, v53
    v_and_b32 v53, 0xffff0000, v53
    v_lshlrev_b32 v54, 16, v55
    v_and_b32 v55, 0xffff0000, v55
    v_lshlrev_b32 v56, 16, v57
    v_and_b32 v57, 0xffff0000, v57
    v_lshlrev_b32 v58, 16, v59
    v_and_b32 v59, 0xffff0000, v59
    v_lshlrev_b32 v60, 16, v61
    v_and_b32 v61, 0xffff0000, v61
    v_lshlrev_b32 v62, 16, v63
    v_and_b32 v63, 0xffff0000, v63
    v_mul_f32 v48, 0x3db504f3, v48
    v_mul_f32 v49, 0x3db504f3, v49
    v_mul_f32 v50, 0x3db504f3, v50
    v_mul_f32 v51, 0x3db504f3, v51
    v_mul_f32 v52, 0x3db504f3, v52
    v_mul_f32 v53, 0x3db504f3, v53
    v_mul_f32 v54, 0x3db504f3, v54
    v_mul_f32 v55, 0x3db504f3, v55
    v_mul_f32 v56, 0x3db504f3, v56
    v_mul_f32 v57, 0x3db504f3, v57
    v_mul_f32 v58, 0x3db504f3, v58
    v_mul_f32 v59, 0x3db504f3, v59
    v_mul_f32 v60, 0x3db504f3, v60
    v_mul_f32 v61, 0x3db504f3, v61
    v_mul_f32 v62, 0x3db504f3, v62
    v_mul_f32 v63, 0x3db504f3, v63
    v_cvt_pk_bf16_f32 v49, v48, v49
    v_cvt_pk_bf16_f32 v51, v50, v51
    v_cvt_pk_bf16_f32 v53, v52, v53
    v_cvt_pk_bf16_f32 v55, v54, v55
    v_cvt_pk_bf16_f32 v57, v56, v57
    v_cvt_pk_bf16_f32 v59, v58, v59
    v_cvt_pk_bf16_f32 v61, v60, v61
    v_cvt_pk_bf16_f32 v63, v62, v63
    v_lshlrev_b32 v48, 16, v49
    v_and_b32 v49, 0xffff0000, v49
    v_lshlrev_b32 v50, 16, v51
    v_and_b32 v51, 0xffff0000, v51
    v_lshlrev_b32 v52, 16, v53
    v_and_b32 v53, 0xffff0000, v53
    v_lshlrev_b32 v54, 16, v55
    v_and_b32 v55, 0xffff0000, v55
    v_lshlrev_b32 v56, 16, v57
    v_and_b32 v57, 0xffff0000, v57
    v_lshlrev_b32 v58, 16, v59
    v_and_b32 v59, 0xffff0000, v59
    v_lshlrev_b32 v60, 16, v61
    v_and_b32 v61, 0xffff0000, v61
    v_lshlrev_b32 v62, 16, v63
    v_and_b32 v63, 0xffff0000, v63
    v_max3_f32 v44, v48, v49, v50
    v_max3_f32 v44, v44, v51, v52
    v_max3_f32 v44, v44, v53, v54
    v_max3_f32 v44, v44, v55, v56
    v_max3_f32 v44, v44, v57, v58
    v_max3_f32 v44, v44, v59, v60
    v_max3_f32 v44, v44, v61, v62
    v_max_f32 v44, v44, v63
    s_nop 1
    v_max_f32_dpp v44, v44, v44 row_ror:4 row_mask:0xf bank_mask:0xf
    s_nop 1
    v_max_f32_dpp v44, v44, v44 row_ror:8 row_mask:0xf bank_mask:0xf
    s_nop 1
    v_max_f32_dpp v44, v44, v44 row_bcast:15 row_mask:0xa bank_mask:0xf
    s_nop 1
    v_max_f32_dpp v44, v44, v44 row_bcast:31 row_mask:0xc bank_mask:0xf
    s_nop 0
    v_readlane_b32 s60, v44, 63
    v_mov_b32 v45, 0xbfb8aa3b
    s_nop 0
    v_mul_f32 v45, s60, v45
    v_fmamk_f32 v48, v48, 0x3fb8aa3b, v45
    v_fmamk_f32 v49, v49, 0x3fb8aa3b, v45
    v_fmamk_f32 v50, v50, 0x3fb8aa3b, v45
    v_fmamk_f32 v51, v51, 0x3fb8aa3b, v45
    v_fmamk_f32 v52, v52, 0x3fb8aa3b, v45
    v_fmamk_f32 v53, v53, 0x3fb8aa3b, v45
    v_fmamk_f32 v54, v54, 0x3fb8aa3b, v45
    v_fmamk_f32 v55, v55, 0x3fb8aa3b, v45
    v_fmamk_f32 v56, v56, 0x3fb8aa3b, v45
    v_fmamk_f32 v57, v57, 0x3fb8aa3b, v45
    v_fmamk_f32 v58, v58, 0x3fb8aa3b, v45
    v_fmamk_f32 v59, v59, 0x3fb8aa3b, v45
    v_fmamk_f32 v60, v60, 0x3fb8aa3b, v45
    v_fmamk_f32 v61, v61, 0x3fb8aa3b, v45
    v_fmamk_f32 v62, v62, 0x3fb8aa3b, v45
    v_fmamk_f32 v63, v63, 0x3fb8aa3b, v45
    v_exp_f32 v48, v48
    v_exp_f32 v49, v49
    v_exp_f32 v50, v50
    v_exp_f32 v51, v51
    v_exp_f32 v52, v52
    v_exp_f32 v53, v53
    v_exp_f32 v54, v54
    v_exp_f32 v55, v55
    v_exp_f32 v56, v56
    v_exp_f32 v57, v57
    v_exp_f32 v58, v58
    v_exp_f32 v59, v59
    v_exp_f32 v60, v60
    v_exp_f32 v61, v61
    v_exp_f32 v62, v62
    v_exp_f32 v63, v63
    v_sub_f32 v16, 0, v45
    v_add_f32 v44, v48, v49
    v_add_f32 v46, v50, v51
    v_add_f32 v44, v44, v52
    v_add_f32 v46, v46, v53
    v_add_f32 v44, v44, v54
    v_add_f32 v46, v46, v55
    v_add_f32 v44, v44, v56
    v_add_f32 v46, v46, v57
    v_add_f32 v44, v44, v58
    v_add_f32 v46, v46, v59
    v_add_f32 v44, v44, v60
    v_add_f32 v46, v46, v61
    v_add_f32 v44, v44, v62
    v_add_f32 v46, v46, v63
    v_add_f32 v44, v44, v46
    v_cvt_pk_bf16_f32 v48, v48, v48
    v_cvt_pk_bf16_f32 v49, v49, v49
    v_cvt_pk_bf16_f32 v50, v50, v50
    v_cvt_pk_bf16_f32 v51, v51, v51
    v_cvt_pk_bf16_f32 v52, v52, v52
    v_cvt_pk_bf16_f32 v53, v53, v53
    v_cvt_pk_bf16_f32 v54, v54, v54
    v_cvt_pk_bf16_f32 v55, v55, v55
    v_cvt_pk_bf16_f32 v56, v56, v56
    v_cvt_pk_bf16_f32 v57, v57, v57
    v_cvt_pk_bf16_f32 v58, v58, v58
    v_cvt_pk_bf16_f32 v59, v59, v59
    v_cvt_pk_bf16_f32 v60, v60, v60
    v_cvt_pk_bf16_f32 v61, v61, v61
    v_cvt_pk_bf16_f32 v62, v62, v62
    v_cvt_pk_bf16_f32 v63, v63, v63
    v_add_f32_dpp v44, v44, v44 row_ror:4 row_mask:0xf bank_mask:0xf
    s_nop 1
    v_add_f32_dpp v44, v44, v44 row_ror:8 row_mask:0xf bank_mask:0xf
    s_nop 1
    v_add_f32_dpp v44, v44, v44 row_bcast:15 row_mask:0xa bank_mask:0xf
    s_nop 1
    v_add_f32_dpp v44, v44, v44 row_bcast:31 row_mask:0xc bank_mask:0xf
    s_nop 0
    v_readlane_b32 s60, v44, 63
    s_nop 1
    v_mov_b32 v17, s60
    v_lshrrev_b32 v44, 6, v0
    v_lshlrev_b32 v44, 3, v44
    ds_write_b64 v44, v[16:17] offset:7936
    v_and_b32_dpp v28, v48, v20 row_newbcast:0 row_mask:0xf bank_mask:0xf
    v_and_b32_dpp v29, v48, v21 row_newbcast:0 row_mask:0xf bank_mask:0xf
    v_and_b32_dpp v30, v48, v22 row_newbcast:0 row_mask:0xf bank_mask:0xf
    v_and_b32_dpp v31, v48, v23 row_newbcast:0 row_mask:0xf bank_mask:0xf
    s_waitcnt vmcnt(15)
    s_nop 0
    v_mfma_f32_16x16x32_bf16 v[36:39], v[28:31], a[0:3], 0
    s_mov_b32 s59, 12288
    buffer_load_dwordx4 v[140:143], v3, s[20:23], s59 offen
    buffer_load_dwordx4 a[28:31], v1, s[12:15], s3 offen offset:3072 nt
    s_mov_b32 s3, 32768
    buffer_load_dwordx4 a[32:35], v1, s[12:15], s3 offen offset:0 nt
    s_mov_b32 s59, 16384
    buffer_load_dwordx4 v[144:147], v3, s[20:23], s59 offen
    buffer_load_dwordx4 a[36:39], v1, s[12:15], s3 offen offset:1024 nt
    v_and_b32_dpp v32, v48, v20 row_newbcast:4 row_mask:0xf bank_mask:0xf
    v_and_b32_dpp v33, v48, v21 row_newbcast:4 row_mask:0xf bank_mask:0xf
    v_and_b32_dpp v34, v48, v22 row_newbcast:4 row_mask:0xf bank_mask:0xf
    v_and_b32_dpp v35, v48, v23 row_newbcast:4 row_mask:0xf bank_mask:0xf
    s_waitcnt vmcnt(19)
    s_nop 0
    v_mfma_f32_16x16x32_bf16 v[36:39], v[32:35], a[4:7], v[36:39]
    s_mov_b32 s59, 20480
    buffer_load_dwordx4 v[148:151], v3, s[20:23], s59 offen
    v_and_b32_dpp v28, v48, v20 row_newbcast:8 row_mask:0xf bank_mask:0xf
    v_and_b32_dpp v29, v48, v21 row_newbcast:8 row_mask:0xf bank_mask:0xf
    v_and_b32_dpp v30, v48, v22 row_newbcast:8 row_mask:0xf bank_mask:0xf
    v_and_b32_dpp v31, v48, v23 row_newbcast:8 row_mask:0xf bank_mask:0xf
    s_waitcnt vmcnt(19)
    s_nop 0
    v_mfma_f32_16x16x32_bf16 v[36:39], v[28:31], a[8:11], v[36:39]
    buffer_load_dwordx4 a[40:43], v1, s[12:15], s3 offen offset:2048 nt
    v_and_b32_dpp v32, v48, v20 row_newbcast:12 row_mask:0xf bank_mask:0xf
    v_and_b32_dpp v33, v48, v21 row_newbcast:12 row_mask:0xf bank_mask:0xf
    v_and_b32_dpp v34, v48, v22 row_newbcast:12 row_mask:0xf bank_mask:0xf
    v_and_b32_dpp v35, v48, v23 row_newbcast:12 row_mask:0xf bank_mask:0xf
    s_waitcnt vmcnt(18)
    s_nop 0
    v_mfma_f32_16x16x32_bf16 v[36:39], v[32:35], a[12:15], v[36:39]
    buffer_load_dwordx4 a[44:47], v1, s[12:15], s3 offen offset:3072 nt
    s_mov_b32 s59, 24576
    buffer_load_dwordx4 v[152:155], v3, s[20:23], s59 offen
    v_and_b32_dpp v28, v49, v20 row_newbcast:0 row_mask:0xf bank_mask:0xf
    v_and_b32_dpp v29, v49, v21 row_newbcast:0 row_mask:0xf bank_mask:0xf
    v_and_b32_dpp v30, v49, v22 row_newbcast:0 row_mask:0xf bank_mask:0xf
    v_and_b32_dpp v31, v49, v23 row_newbcast:0 row_mask:0xf bank_mask:0xf
    s_waitcnt vmcnt(18)
    s_nop 0
    v_mfma_f32_16x16x32_bf16 v[36:39], v[28:31], a[16:19], v[36:39]
    s_mov_b32 s3, 49152
    buffer_load_dwordx4 a[48:51], v1, s[12:15], s3 offen offset:0 nt
    s_mov_b32 s59, 28672
    buffer_load_dwordx4 v[156:159], v3, s[20:23], s59 offen
    v_and_b32_dpp v32, v49, v20 row_newbcast:4 row_mask:0xf bank_mask:0xf
    v_and_b32_dpp v33, v49, v21 row_newbcast:4 row_mask:0xf bank_mask:0xf
    v_and_b32_dpp v34, v49, v22 row_newbcast:4 row_mask:0xf bank_mask:0xf
    v_and_b32_dpp v35, v49, v23 row_newbcast:4 row_mask:0xf bank_mask:0xf
    s_waitcnt vmcnt(13)
    s_nop 0
    v_mfma_f32_16x16x32_bf16 v[36:39], v[32:35], a[20:23], v[36:39]
    buffer_load_dwordx4 a[52:55], v1, s[12:15], s3 offen offset:1024 nt
    buffer_load_dwordx4 a[56:59], v1, s[12:15], s3 offen offset:2048 nt
    s_mov_b32 s59, 32768
    buffer_load_dwordx4 v[160:163], v3, s[20:23], s59 offen
    buffer_load_dwordx4 a[60:63], v1, s[12:15], s3 offen offset:3072 nt
    s_mov_b32 s59, 36864
    buffer_load_dwordx4 v[164:167], v3, s[20:23], s59 offen
    s_mov_b32 s3, 65536
    buffer_load_dwordx4 a[64:67], v1, s[12:15], s3 offen offset:0 nt
    buffer_load_dwordx4 a[68:71], v1, s[12:15], s3 offen offset:1024 nt
    v_and_b32_dpp v28, v49, v20 row_newbcast:8 row_mask:0xf bank_mask:0xf
    v_and_b32_dpp v29, v49, v21 row_newbcast:8 row_mask:0xf bank_mask:0xf
    v_and_b32_dpp v30, v49, v22 row_newbcast:8 row_mask:0xf bank_mask:0xf
    v_and_b32_dpp v31, v49, v23 row_newbcast:8 row_mask:0xf bank_mask:0xf
    v_lshlrev_b32 v44, 16, v88
    v_lshlrev_b32 v45, 16, v92
    v_and_b32 v88, 0xffff0000, v88
    v_and_b32 v92, 0xffff0000, v92
    v_mul_f32 v44, v44, v45
    v_mul_f32 v45, v88, v92
    v_cvt_pk_bf16_f32 v44, v44, v45
    v_and_b32 v45, 0xffff0000, v44
    v_lshlrev_b32 v44, 16, v44
    v_add_f32 v46, v44, v45
    v_lshlrev_b32 v44, 16, v89
    v_lshlrev_b32 v45, 16, v93
    v_and_b32 v89, 0xffff0000, v89
    v_and_b32 v93, 0xffff0000, v93
    v_mul_f32 v44, v44, v45
    v_mul_f32 v45, v89, v93
    v_cvt_pk_bf16_f32 v44, v44, v45
    v_and_b32 v45, 0xffff0000, v44
    v_lshlrev_b32 v44, 16, v44
    v_add_f32 v44, v44, v45
    v_add_f32 v46, v46, v44
    v_lshlrev_b32 v44, 16, v90
    v_lshlrev_b32 v45, 16, v94
    v_and_b32 v90, 0xffff0000, v90
    v_and_b32 v94, 0xffff0000, v94
    v_mul_f32 v44, v44, v45
    v_mul_f32 v45, v90, v94
    v_cvt_pk_bf16_f32 v44, v44, v45
    v_and_b32 v45, 0xffff0000, v44
    v_lshlrev_b32 v44, 16, v44
    v_add_f32 v44, v44, v45
    v_add_f32 v46, v46, v44
    v_lshlrev_b32 v44, 16, v91
    v_lshlrev_b32 v45, 16, v95
    v_and_b32 v91, 0xffff0000, v91
    v_and_b32 v95, 0xffff0000, v95
    v_mul_f32 v44, v44, v45
    v_mul_f32 v45, v91, v95
    v_cvt_pk_bf16_f32 v44, v44, v45
    v_and_b32 v45, 0xffff0000, v44
    v_lshlrev_b32 v44, 16, v44
    v_add_f32 v44, v44, v45
    v_add_f32 v46, v46, v44
    s_nop 1
    v_add_f32_dpp v46, v46, v46 row_ror:1 row_mask:0xf bank_mask:0xf
    s_nop 1
    v_add_f32_dpp v46, v46, v46 row_ror:2 row_mask:0xf bank_mask:0xf
    s_nop 1
    v_add_f32_dpp v46, v46, v46 row_ror:4 row_mask:0xf bank_mask:0xf
    s_nop 1
    v_add_f32_dpp v46, v46, v46 row_ror:8 row_mask:0xf bank_mask:0xf
    s_nop 1
    v_add_f32_dpp v46, v46, v46 row_bcast:15 row_mask:0xa bank_mask:0xf
    s_nop 1
    v_add_f32_dpp v46, v46, v46 row_bcast:31 row_mask:0xc bank_mask:0xf
    s_nop 0
    v_readlane_b32 s57, v46, 63
    s_nop 1
    v_mov_b32 v11, s57
    v_cvt_pk_bf16_f32 v11, v11, v11
    v_and_b32 v11, 0xffff0000, v11
    v_mul_f32 v11, 0xbfb8aa3b, v11
    v_exp_f32 v11, v11
    s_nop 0
    v_add_f32 v11, 1.0, v11
    v_rcp_f32 v11, v11
    s_nop 0
    v_cvt_pk_bf16_f32 v11, v11, v11
    v_and_b32 v11, 0xffff0000, v11
    v_sub_f32 v14, 1.0, v11
    v_cvt_pk_bf16_f32 v14, v14, v14
    v_and_b32 v14, 0xffff0000, v14
    s_waitcnt vmcnt(18)
    v_mfma_f32_16x16x32_bf16 v[36:39], v[28:31], a[24:27], v[36:39]
    s_mov_b32 s59, 40960
    buffer_load_dwordx4 v[168:171], v3, s[20:23], s59 offen
    buffer_load_dwordx4 a[72:75], v1, s[12:15], s3 offen offset:2048 nt
    v_and_b32_dpp v32, v49, v20 row_newbcast:12 row_mask:0xf bank_mask:0xf
    v_and_b32_dpp v33, v49, v21 row_newbcast:12 row_mask:0xf bank_mask:0xf
    v_and_b32_dpp v34, v49, v22 row_newbcast:12 row_mask:0xf bank_mask:0xf
    v_and_b32_dpp v35, v49, v23 row_newbcast:12 row_mask:0xf bank_mask:0xf
    v_xor_b32 v12, v12, v10
    v_xor_b32 v13, v13, v10
    v_or_b32 v44, v12, v13
    v_and_b32 v44, 0xff, v44
    v_cmp_ne_u32 vcc, 0, v44
    s_nop 0
    s_and_b64 vcc, vcc, s[62:63]
    s_cbranch_vccz L_fg_ok
    s_mov_b32 s61, 1048576
L_fg_spin:
    s_nop 4
    buffer_load_dword v12, v4, s[36:39], 0 offen sc1
    buffer_load_dword v13, v43, s[36:39], 0 offen sc1
    s_waitcnt vmcnt(0)
    v_xor_b32 v12, v12, v10
    v_xor_b32 v13, v13, v10
    v_or_b32 v44, v12, v13
    v_and_b32 v44, 0xff, v44
    v_cmp_ne_u32 vcc, 0, v44
    s_nop 0
    s_and_b64 vcc, vcc, s[62:63]
    s_cbranch_vccz L_fg_ok
    s_sub_u32 s61, s61, 1
    s_cmp_lg_u32 s61, 0
    s_cbranch_scc1 L_fg_spin
L_fg_ok:
    s_nop 4
    v_cndmask_b32 v12, 0, v12, s[62:63]
    v_cndmask_b32 v13, 0, v13, s[62:63]
    s_nop 0
    v_add_f32_dpp v12, v12, v12 row_ror:4 row_mask:0xf bank_mask:0xf
    v_add_f32_dpp v13, v13, v13 row_ror:4 row_mask:0xf bank_mask:0xf
    s_nop 0
    v_add_f32_dpp v12, v12, v12 row_ror:8 row_mask:0xf bank_mask:0xf
    v_add_f32_dpp v13, v13, v13 row_ror:8 row_mask:0xf bank_mask:0xf
    v_cvt_pk_bf16_f32 v12, v12, v12
    v_and_b32 v12, 0xffff0000, v12
    v_cvt_pk_bf16_f32 v13, v13, v13
    v_and_b32 v13, 0xffff0000, v13
    v_mov_b32 v46, 0xc0135761
    v_mul_f32 v44, v12, v12
    v_fmamk_f32 v44, v44, 0xbdd2d3e8, v46
    v_mul_f32 v44, v44, v12
    v_exp_f32 v44, v44
    s_nop 0
    v_add_f32 v44, 1.0, v44
    v_rcp_f32 v44, v44
    s_nop 0
    v_mul_f32 v12, v12, v44
    v_cvt_pk_bf16_f32 v12, v12, v12
    v_and_b32 v12, 0xffff0000, v12
    v_mul_f32 v12, v12, v13
    v_cvt_pk_bf16_f32 v12, v12, v12
    s_nop 1
    v_and_b32_dpp v104, v12, v20 row_newbcast:0 row_mask:0xf bank_mask:0xf
    v_and_b32_dpp v105, v12, v21 row_newbcast:0 row_mask:0xf bank_mask:0xf
    v_and_b32_dpp v106, v12, v22 row_newbcast:0 row_mask:0xf bank_mask:0xf
    v_and_b32_dpp v107, v12, v23 row_newbcast:0 row_mask:0xf bank_mask:0xf
    s_nop 1
    v_mfma_f32_16x16x32_bf16 v[40:43], v[104:107], v[64:67], 0
    v_and_b32_dpp v104, v12, v20 row_newbcast:1 row_mask:0xf bank_mask:0xf
    v_and_b32_dpp v105, v12, v21 row_newbcast:1 row_mask:0xf bank_mask:0xf
    v_and_b32_dpp v106, v12, v22 row_newbcast:1 row_mask:0xf bank_mask:0xf
    v_and_b32_dpp v107, v12, v23 row_newbcast:1 row_mask:0xf bank_mask:0xf
    s_nop 1
    v_mfma_f32_16x16x32_bf16 v[40:43], v[104:107], v[68:71], v[40:43]
    v_and_b32_dpp v104, v12, v20 row_newbcast:2 row_mask:0xf bank_mask:0xf
    v_and_b32_dpp v105, v12, v21 row_newbcast:2 row_mask:0xf bank_mask:0xf
    v_and_b32_dpp v106, v12, v22 row_newbcast:2 row_mask:0xf bank_mask:0xf
    v_and_b32_dpp v107, v12, v23 row_newbcast:2 row_mask:0xf bank_mask:0xf
    s_nop 1
    v_mfma_f32_16x16x32_bf16 v[40:43], v[104:107], v[72:75], v[40:43]
    v_and_b32_dpp v104, v12, v20 row_newbcast:3 row_mask:0xf bank_mask:0xf
    v_and_b32_dpp v105, v12, v21 row_newbcast:3 row_mask:0xf bank_mask:0xf
    v_and_b32_dpp v106, v12, v22 row_newbcast:3 row_mask:0xf bank_mask:0xf
    v_and_b32_dpp v107, v12, v23 row_newbcast:3 row_mask:0xf bank_mask:0xf
    s_nop 1
    v_mfma_f32_16x16x32_bf16 v[40:43], v[104:107], v[76:79], v[40:43]
    s_waitcnt vmcnt(18)
    v_mfma_f32_16x16x32_bf16 v[36:39], v[32:35], a[28:31], v[36:39]
    buffer_load_dwordx4 a[76:79], v1, s[12:15], s3 offen offset:3072 nt
    s_mov_b32 s59, 45056
    buffer_load_dwordx4 v[172:175], v3, s[20:23], s59 offen
    v_and_b32_dpp v28, v50, v20 row_newbcast:0 row_mask:0xf bank_mask:0xf
    v_and_b32_dpp v29, v50, v21 row_newbcast:0 row_mask:0xf bank_mask:0xf
    v_and_b32_dpp v30, v50, v22 row_newbcast:0 row_mask:0xf bank_mask:0xf
    v_and_b32_dpp v31, v50, v23 row_newbcast:0 row_mask:0xf bank_mask:0xf
    s_waitcnt vmcnt(19)
    s_nop 0
    v_mfma_f32_16x16x32_bf16 v[36:39], v[28:31], a[32:35], v[36:39]
    s_mov_b32 s3, 81920
    buffer_load_dwordx4 a[80:83], v1, s[12:15], s3 offen offset:0 nt
    v_and_b32_dpp v32, v50, v20 row_newbcast:4 row_mask:0xf bank_mask:0xf
    v_and_b32_dpp v33, v50, v21 row_newbcast:4 row_mask:0xf bank_mask:0xf
    v_and_b32_dpp v34, v50, v22 row_newbcast:4 row_mask:0xf bank_mask:0xf
    v_and_b32_dpp v35, v50, v23 row_newbcast:4 row_mask:0xf bank_mask:0xf
    s_waitcnt lgkmcnt(0)
    s_barrier
    s_and_b32 s57, s47, 0xc0
    s_cbranch_scc1 L_noml
    v_and_b32 v44, 3, v0
    v_lshlrev_b32 v44, 3, v44
    ds_read_b64 v[46:47], v44 offset:7936
    v_mov_b32 v102, v18
    v_mov_b32 v103, v19
    s_waitcnt lgkmcnt(0)
    v_max_f32_dpp v100, v46, v46 quad_perm:[1,0,3,2] row_mask:0xf bank_mask:0xf
    s_nop 1
    v_max_f32_dpp v100, v100, v100 quad_perm:[2,3,0,1] row_mask:0xf bank_mask:0xf
    v_sub_f32 v46, v46, v100
    v_exp_f32 v46, v46
    s_nop 0
    v_mul_f32 v46, v46, v47
    s_nop 1
    v_add_f32_dpp v46, v46, v46 quad_perm:[1,0,3,2] row_mask:0xf bank_mask:0xf
    s_nop 1
    v_add_f32_dpp v101, v46, v46 quad_perm:[2,3,0,1] row_mask:0xf bank_mask:0xf
    buffer_store_dwordx4 v[100:103], v7, s[36:39], 0 offen sc1
L_noml:
    s_nop 1
    s_waitcnt vmcnt(18)
    v_mfma_f32_16x16x32_bf16 v[36:39], v[32:35], a[36:39], v[36:39]
    s_mov_b32 s59, 49152
    buffer_load_dwordx4 v[176:179], v3, s[20:23], s59 offen
    buffer_load_dwordx4 a[84:87], v1, s[12:15], s3 offen offset:1024 nt
    v_and_b32_dpp v28, v50, v20 row_newbcast:8 row_mask:0xf bank_mask:0xf
    v_and_b32_dpp v29, v50, v21 row_newbcast:8 row_mask:0xf bank_mask:0xf
    v_and_b32_dpp v30, v50, v22 row_newbcast:8 row_mask:0xf bank_mask:0xf
    v_and_b32_dpp v31, v50, v23 row_newbcast:8 row_mask:0xf bank_mask:0xf
    v_mul_f32 v40, v40, v14
    v_mul_f32 v41, v41, v14
    v_mul_f32 v42, v42, v14
    v_mul_f32 v43, v43, v14
    v_lshrrev_b32 v45, 6, v0
    v_lshlrev_b32 v45, 9, v45
    v_and_b32 v46, 15, v0
    v_lshl_add_u32 v44, v46, 5, v45
    v_bfe_u32 v47, v0, 4, 1
    v_lshl_add_u32 v44, v47, 4, v44
    ds_write_b128 v44, v[40:43] offset:5632
    v_bfe_u32 v47, v0, 4, 2
    v_lshl_add_u32 v45, v47, 7, v45
    v_lshl_add_u32 v45, v46, 2, v45
    s_waitcnt lgkmcnt(0)
    ds_read_b32 v116, v45 offset:5632
    ds_read_b32 v117, v45 offset:5696
    s_waitcnt vmcnt(18)
    v_mfma_f32_16x16x32_bf16 v[36:39], v[28:31], a[40:43], v[36:39]
    buffer_load_dwordx4 a[88:91], v1, s[12:15], s3 offen offset:2048 nt
    s_mov_b32 s59, 53248
    buffer_load_dwordx4 v[180:183], v3, s[20:23], s59 offen
    v_and_b32_dpp v32, v50, v20 row_newbcast:12 row_mask:0xf bank_mask:0xf
    v_and_b32_dpp v33, v50, v21 row_newbcast:12 row_mask:0xf bank_mask:0xf
    v_and_b32_dpp v34, v50, v22 row_newbcast:12 row_mask:0xf bank_mask:0xf
    v_and_b32_dpp v35, v50, v23 row_newbcast:12 row_mask:0xf bank_mask:0xf
    s_waitcnt vmcnt(19)
    s_nop 0
    v_mfma_f32_16x16x32_bf16 v[36:39], v[32:35], a[44:47], v[36:39]
    buffer_load_dwordx4 a[92:95], v1, s[12:15], s3 offen offset:3072 nt
    v_and_b32_dpp v28, v51, v20 row_newbcast:0 row_mask:0xf bank_mask:0xf
    v_and_b32_dpp v29, v51, v21 row_newbcast:0 row_mask:0xf bank_mask:0xf
    v_and_b32_dpp v30, v51, v22 row_newbcast:0 row_mask:0xf bank_mask:0xf
    v_and_b32_dpp v31, v51, v23 row_newbcast:0 row_mask:0xf bank_mask:0xf
    s_waitcnt vmcnt(18)
    s_nop 0
    v_mfma_f32_16x16x32_bf16 v[36:39], v[28:31], a[48:51], v[36:39]
    s_mov_b32 s59, 57344
    buffer_load_dwordx4 v[184:187], v3, s[20:23], s59 offen
    s_mov_b32 s3, 98304
    buffer_load_dwordx4 a[96:99], v1, s[12:15], s3 offen offset:0 nt
    v_and_b32_dpp v32, v51, v20 row_newbcast:4 row_mask:0xf bank_mask:0xf
    v_and_b32_dpp v33, v51, v21 row_newbcast:4 row_mask:0xf bank_mask:0xf
    v_and_b32_dpp v34, v51, v22 row_newbcast:4 row_mask:0xf bank_mask:0xf
    v_and_b32_dpp v35, v51, v23 row_newbcast:4 row_mask:0xf bank_mask:0xf
    s_waitcnt vmcnt(18)
    s_nop 0
    v_mfma_f32_16x16x32_bf16 v[36:39], v[32:35], a[52:55], v[36:39]
    buffer_load_dwordx4 a[100:103], v1, s[12:15], s3 offen offset:1024 nt
    s_mov_b32 s59, 61440
    buffer_load_dwordx4 v[188:191], v3, s[20:23], s59 offen
    v_and_b32_dpp v28, v51, v20 row_newbcast:8 row_mask:0xf bank_mask:0xf
    v_and_b32_dpp v29, v51, v21 row_newbcast:8 row_mask:0xf bank_mask:0xf
    v_and_b32_dpp v30, v51, v22 row_newbcast:8 row_mask:0xf bank_mask:0xf
    v_and_b32_dpp v31, v51, v23 row_newbcast:8 row_mask:0xf bank_mask:0xf
    v_lshrrev_b32 v45, 6, v0
    v_mul_u32_u24 v45, 9216, v45
    v_add_u32 v45, 8192, v45
    v_bfe_u32 v47, v0, 4, 2
    v_mul_u32_u24 v44, 288, v47
    v_and_b32 v46, 15, v0
    v_lshl_add_u32 v44, v46, 4, v44
    v_add_u32 v122, v44, v45
    v_bfe_u32 v44, v0, 2, 2
    v_lshl_add_u32 v44, v47, 3, v44
    v_mul_u32_u24 v44, 288, v44
    v_and_b32 v46, 3, v0
    v_lshl_add_u32 v44, v46, 3, v44
    v_add_u32 v123, v44, v45
    v_mul_u32_u24 v44, 320, v46
    v_lshl_add_u32 v118, v47, 4, v44
    s_waitcnt lgkmcnt(0)
    ds_write_b128 v122, v[128:131] offset:0
    ds_write_b128 v122, v[132:135] offset:1152
    ds_write_b128 v122, v[136:139] offset:2304
    ds_write_b128 v122, v[140:143] offset:3456
    ds_write_b128 v122, v[144:147] offset:4608
    ds_write_b128 v122, v[148:151] offset:5760
    ds_write_b128 v122, v[152:155] offset:6912
    ds_write_b128 v122, v[156:159] offset:8064
    s_waitcnt lgkmcnt(0)
    ds_read_b64_tr_b16 v[128:129], v123 offset:0
    ds_read_b64_tr_b16 v[130:131], v123 offset:1152
    ds_read_b64_tr_b16 v[132:133], v123 offset:32
    ds_read_b64_tr_b16 v[134:135], v123 offset:1184
    ds_read_b64_tr_b16 v[136:137], v123 offset:64
    ds_read_b64_tr_b16 v[138:139], v123 offset:1216
    ds_read_b64_tr_b16 v[140:141], v123 offset:96
    ds_read_b64_tr_b16 v[142:143], v123 offset:1248
    ds_read_b64_tr_b16 v[144:145], v123 offset:128
    ds_read_b64_tr_b16 v[146:147], v123 offset:1280
    ds_read_b64_tr_b16 v[148:149], v123 offset:160
    ds_read_b64_tr_b16 v[150:151], v123 offset:1312
    ds_read_b64_tr_b16 v[152:153], v123 offset:192
    ds_read_b64_tr_b16 v[154:155], v123 offset:1344
    ds_read_b64_tr_b16 v[156:157], v123 offset:224
    ds_read_b64_tr_b16 v[158:159], v123 offset:1376
    s_waitcnt vmcnt(19)
    v_mfma_f32_16x16x32_bf16 v[36:39], v[28:31], a[56:59], v[36:39]
    buffer_load_dwordx4 a[104:107], v1, s[12:15], s3 offen offset:2048 nt
    v_and_b32_dpp v32, v51, v20 row_newbcast:12 row_mask:0xf bank_mask:0xf
    v_and_b32_dpp v33, v51, v21 row_newbcast:12 row_mask:0xf bank_mask:0xf
    v_and_b32_dpp v34, v51, v22 row_newbcast:12 row_mask:0xf bank_mask:0xf
    v_and_b32_dpp v35, v51, v23 row_newbcast:12 row_mask:0xf bank_mask:0xf
    s_waitcnt vmcnt(18)
    s_nop 0
    v_mfma_f32_16x16x32_bf16 v[36:39], v[32:35], a[60:63], v[36:39]
    s_mov_b32 s59, 65536
    buffer_load_dwordx4 v[192:195], v3, s[20:23], s59 offen
    buffer_load_dwordx4 a[108:111], v1, s[12:15], s3 offen offset:3072 nt
    v_and_b32_dpp v28, v52, v20 row_newbcast:0 row_mask:0xf bank_mask:0xf
    v_and_b32_dpp v29, v52, v21 row_newbcast:0 row_mask:0xf bank_mask:0xf
    v_and_b32_dpp v30, v52, v22 row_newbcast:0 row_mask:0xf bank_mask:0xf
    v_and_b32_dpp v31, v52, v23 row_newbcast:0 row_mask:0xf bank_mask:0xf
    s_waitcnt vmcnt(18)
    s_nop 0
    v_mfma_f32_16x16x32_bf16 v[36:39], v[28:31], a[64:67], v[36:39]
    s_mov_b32 s3, 114688
    buffer_load_dwordx4 a[112:115], v1, s[12:15], s3 offen offset:0 nt
    s_mov_b32 s59, 69632
    buffer_load_dwordx4 v[196:199], v3, s[20:23], s59 offen
    v_and_b32_dpp v32, v52, v20 row_newbcast:4 row_mask:0xf bank_mask:0xf
    v_and_b32_dpp v33, v52, v21 row_newbcast:4 row_mask:0xf bank_mask:0xf
    v_and_b32_dpp v34, v52, v22 row_newbcast:4 row_mask:0xf bank_mask:0xf
    v_and_b32_dpp v35, v52, v23 row_newbcast:4 row_mask:0xf bank_mask:0xf
    s_waitcnt vmcnt(19)
    s_nop 0
    v_mfma_f32_16x16x32_bf16 v[36:39], v[32:35], a[68:71], v[36:39]
    buffer_load_dwordx4 a[116:119], v1, s[12:15], s3 offen offset:1024 nt
    v_and_b32_dpp v28, v52, v20 row_newbcast:8 row_mask:0xf bank_mask:0xf
    v_and_b32_dpp v29, v52, v21 row_newbcast:8 row_mask:0xf bank_mask:0xf
    v_and_b32_dpp v30, v52, v22 row_newbcast:8 row_mask:0xf bank_mask:0xf
    v_and_b32_dpp v31, v52, v23 row_newbcast:8 row_mask:0xf bank_mask:0xf
    s_waitcnt vmcnt(18)
    s_nop 0
    v_mfma_f32_16x16x32_bf16 v[36:39], v[28:31], a[72:75], v[36:39]
    s_mov_b32 s59, 73728
    buffer_load_dwordx4 v[200:203], v3, s[20:23], s59 offen
    buffer_load_dwordx4 a[120:123], v1, s[12:15], s3 offen offset:2048 nt
    v_and_b32_dpp v32, v52, v20 row_newbcast:12 row_mask:0xf bank_mask:0xf
    v_and_b32_dpp v33, v52, v21 row_newbcast:12 row_mask:0xf bank_mask:0xf
    v_and_b32_dpp v34, v52, v22 row_newbcast:12 row_mask:0xf bank_mask:0xf
    v_and_b32_dpp v35, v52, v23 row_newbcast:12 row_mask:0xf bank_mask:0xf
    s_waitcnt vmcnt(19)
    s_nop 0
    v_mfma_f32_16x16x32_bf16 v[36:39], v[32:35], a[76:79], v[36:39]
    buffer_load_dwordx4 a[124:127], v1, s[12:15], s3 offen offset:3072 nt
    v_and_b32_dpp v28, v53, v20 row_newbcast:0 row_mask:0xf bank_mask:0xf
    v_and_b32_dpp v29, v53, v21 row_newbcast:0 row_mask:0xf bank_mask:0xf
    v_and_b32_dpp v30, v53, v22 row_newbcast:0 row_mask:0xf bank_mask:0xf
    v_and_b32_dpp v31, v53, v23 row_newbcast:0 row_mask:0xf bank_mask:0xf
    s_waitcnt vmcnt(18)
    s_nop 0
    v_mfma_f32_16x16x32_bf16 v[36:39], v[28:31], a[80:83], v[36:39]
    s_mov_b32 s59, 77824
    buffer_load_dwordx4 v[204:207], v3, s[20:23], s59 offen
    s_mov_b32 s3, 131072
    buffer_load_dwordx4 a[128:131], v1, s[12:15], s3 offen offset:0 nt
    v_and_b32_dpp v32, v53, v20 row_newbcast:4 row_mask:0xf bank_mask:0xf
    v_and_b32_dpp v33, v53, v21 row_newbcast:4 row_mask:0xf bank_mask:0xf
    v_and_b32_dpp v34, v53, v22 row_newbcast:4 row_mask:0xf bank_mask:0xf
    v_and_b32_dpp v35, v53, v23 row_newbcast:4 row_mask:0xf bank_mask:0xf
    s_waitcnt vmcnt(18)
    s_nop 0
    v_mfma_f32_16x16x32_bf16 v[36:39], v[32:35], a[84:87], v[36:39]
    buffer_load_dwordx4 a[132:135], v1, s[12:15], s3 offen offset:1024 nt
    s_mov_b32 s59, 81920
    buffer_load_dwordx4 v[208:211], v3, s[20:23], s59 offen
    v_and_b32_dpp v28, v53, v20 row_newbcast:8 row_mask:0xf bank_mask:0xf
    v_and_b32_dpp v29, v53, v21 row_newbcast:8 row_mask:0xf bank_mask:0xf
    v_and_b32_dpp v30, v53, v22 row_newbcast:8 row_mask:0xf bank_mask:0xf
    v_and_b32_dpp v31, v53, v23 row_newbcast:8 row_mask:0xf bank_mask:0xf
    s_waitcnt vmcnt(19)
    s_nop 0
    v_mfma_f32_16x16x32_bf16 v[36:39], v[28:31], a[88:91], v[36:39]
    buffer_load_dwordx4 a[136:139], v1, s[12:15], s3 offen offset:2048 nt
    v_and_b32_dpp v32, v53, v20 row_newbcast:12 row_mask:0xf bank_mask:0xf
    v_and_b32_dpp v33, v53, v21 row_newbcast:12 row_mask:0xf bank_mask:0xf
    v_and_b32_dpp v34, v53, v22 row_newbcast:12 row_mask:0xf bank_mask:0xf
    v_and_b32_dpp v35, v53, v23 row_newbcast:12 row_mask:0xf bank_mask:0xf
    s_waitcnt vmcnt(18)
    s_nop 0
    v_mfma_f32_16x16x32_bf16 v[36:39], v[32:35], a[92:95], v[36:39]
    s_mov_b32 s59, 86016
    buffer_load_dwordx4 v[212:215], v3, s[20:23], s59 offen
    buffer_load_dwordx4 a[140:143], v1, s[12:15], s3 offen offset:3072 nt
    v_and_b32_dpp v28, v54, v20 row_newbcast:0 row_mask:0xf bank_mask:0xf
    v_and_b32_dpp v29, v54, v21 row_newbcast:0 row_mask:0xf bank_mask:0xf
    v_and_b32_dpp v30, v54, v22 row_newbcast:0 row_mask:0xf bank_mask:0xf
    v_and_b32_dpp v31, v54, v23 row_newbcast:0 row_mask:0xf bank_mask:0xf
    s_waitcnt vmcnt(18)
    s_nop 0
    v_mfma_f32_16x16x32_bf16 v[36:39], v[28:31], a[96:99], v[36:39]
    s_mov_b32 s3, 147456
    buffer_load_dwordx4 a[144:147], v1, s[12:15], s3 offen offset:0 nt
    s_mov_b32 s59, 90112
    buffer_load_dwordx4 v[216:219], v3, s[20:23], s59 offen
    v_and_b32_dpp v32, v54, v20 row_newbcast:4 row_mask:0xf bank_mask:0xf
    v_and_b32_dpp v33, v54, v21 row_newbcast:4 row_mask:0xf bank_mask:0xf
    v_and_b32_dpp v34, v54, v22 row_newbcast:4 row_mask:0xf bank_mask:0xf
    v_and_b32_dpp v35, v54, v23 row_newbcast:4 row_mask:0xf bank_mask:0xf
    s_waitcnt vmcnt(19)
    s_nop 0
    v_mfma_f32_16x16x32_bf16 v[36:39], v[32:35], a[100:103], v[36:39]
    buffer_load_dwordx4 a[148:151], v1, s[12:15], s3 offen offset:1024 nt
    v_and_b32_dpp v28, v54, v20 row_newbcast:8 row_mask:0xf bank_mask:0xf
    v_and_b32_dpp v29, v54, v21 row_newbcast:8 row_mask:0xf bank_mask:0xf
    v_and_b32_dpp v30, v54, v22 row_newbcast:8 row_mask:0xf bank_mask:0xf
    v_and_b32_dpp v31, v54, v23 row_newbcast:8 row_mask:0xf bank_mask:0xf
    s_waitcnt vmcnt(18)
    s_nop 0
    v_mfma_f32_16x16x32_bf16 v[36:39], v[28:31], a[104:107], v[36:39]
    s_mov_b32 s59, 94208
    buffer_load_dwordx4 v[220:223], v3, s[20:23], s59 offen
    buffer_load_dwordx4 a[152:155], v1, s[12:15], s3 offen offset:2048 nt
    v_and_b32_dpp v32, v54, v20 row_newbcast:12 row_mask:0xf bank_mask:0xf
    v_and_b32_dpp v33, v54, v21 row_newbcast:12 row_mask:0xf bank_mask:0xf
    v_and_b32_dpp v34, v54, v22 row_newbcast:12 row_mask:0xf bank_mask:0xf
    v_and_b32_dpp v35, v54, v23 row_newbcast:12 row_mask:0xf bank_mask:0xf
    s_waitcnt lgkmcnt(0)
    ds_write_b128 v122, v[160:163] offset:0
    ds_write_b128 v122, v[164:167] offset:1152
    ds_write_b128 v122, v[168:171] offset:2304
    ds_write_b128 v122, v[172:175] offset:3456
    ds_write_b128 v122, v[176:179] offset:4608
    ds_write_b128 v122, v[180:183] offset:5760
    ds_write_b128 v122, v[184:187] offset:6912
    ds_write_b128 v122, v[188:191] offset:8064
    s_waitcnt lgkmcnt(0)
    ds_read_b64_tr_b16 v[160:161], v123 offset:0
    ds_read_b64_tr_b16 v[162:163], v123 offset:1152
    ds_read_b64_tr_b16 v[164:165], v123 offset:32
    ds_read_b64_tr_b16 v[166:167], v123 offset:1184
    ds_read_b64_tr_b16 v[168:169], v123 offset:64
    ds_read_b64_tr_b16 v[170:171], v123 offset:1216
    ds_read_b64_tr_b16 v[172:173], v123 offset:96
    ds_read_b64_tr_b16 v[174:175], v123 offset:1248
    ds_read_b64_tr_b16 v[176:177], v123 offset:128
    ds_read_b64_tr_b16 v[178:179], v123 offset:1280
    ds_read_b64_tr_b16 v[180:181], v123 offset:160
    ds_read_b64_tr_b16 v[182:183], v123 offset:1312
    ds_read_b64_tr_b16 v[184:185], v123 offset:192
    ds_read_b64_tr_b16 v[186:187], v123 offset:1344
    ds_read_b64_tr_b16 v[188:189], v123 offset:224
    ds_read_b64_tr_b16 v[190:191], v123 offset:1376
    s_waitcnt vmcnt(18)
    v_mfma_f32_16x16x32_bf16 v[36:39], v[32:35], a[108:111], v[36:39]
    buffer_load_dwordx4 a[156:159], v1, s[12:15], s3 offen offset:3072 nt
    s_mov_b32 s59, 98304
    buffer_load_dwordx4 v[224:227], v3, s[20:23], s59 offen
    v_and_b32_dpp v28, v55, v20 row_newbcast:0 row_mask:0xf bank_mask:0xf
    v_and_b32_dpp v29, v55, v21 row_newbcast:0 row_mask:0xf bank_mask:0xf
    v_and_b32_dpp v30, v55, v22 row_newbcast:0 row_mask:0xf bank_mask:0xf
    v_and_b32_dpp v31, v55, v23 row_newbcast:0 row_mask:0xf bank_mask:0xf
    s_waitcnt vmcnt(19)
    s_nop 0
    v_mfma_f32_16x16x32_bf16 v[36:39], v[28:31], a[112:115], v[36:39]
    s_mov_b32 s3, 163840
    buffer_load_dwordx4 a[160:163], v1, s[12:15], s3 offen offset:0 nt
    v_and_b32_dpp v32, v55, v20 row_newbcast:4 row_mask:0xf bank_mask:0xf
    v_and_b32_dpp v33, v55, v21 row_newbcast:4 row_mask:0xf bank_mask:0xf
    v_and_b32_dpp v34, v55, v22 row_newbcast:4 row_mask:0xf bank_mask:0xf
    v_and_b32_dpp v35, v55, v23 row_newbcast:4 row_mask:0xf bank_mask:0xf
    s_waitcnt vmcnt(18)
    s_nop 0
    v_mfma_f32_16x16x32_bf16 v[36:39], v[32:35], a[116:119], v[36:39]
    s_mov_b32 s59, 102400
    buffer_load_dwordx4 v[228:231], v3, s[20:23], s59 offen
    buffer_load_dwordx4 a[164:167], v1, s[12:15], s3 offen offset:1024 nt
    v_and_b32_dpp v28, v55, v20 row_newbcast:8 row_mask:0xf bank_mask:0xf
    v_and_b32_dpp v29, v55, v21 row_newbcast:8 row_mask:0xf bank_mask:0xf
    v_and_b32_dpp v30, v55, v22 row_newbcast:8 row_mask:0xf bank_mask:0xf
    v_and_b32_dpp v31, v55, v23 row_newbcast:8 row_mask:0xf bank_mask:0xf
    s_waitcnt vmcnt(18)
    s_nop 0
    v_mfma_f32_16x16x32_bf16 v[36:39], v[28:31], a[120:123], v[36:39]
    buffer_load_dwordx4 a[168:171], v1, s[12:15], s3 offen offset:2048 nt
    s_mov_b32 s59, 106496
    buffer_load_dwordx4 v[232:235], v3, s[20:23], s59 offen
    v_and_b32_dpp v32, v55, v20 row_newbcast:12 row_mask:0xf bank_mask:0xf
    v_and_b32_dpp v33, v55, v21 row_newbcast:12 row_mask:0xf bank_mask:0xf
    v_and_b32_dpp v34, v55, v22 row_newbcast:12 row_mask:0xf bank_mask:0xf
    v_and_b32_dpp v35, v55, v23 row_newbcast:12 row_mask:0xf bank_mask:0xf
    s_waitcnt vmcnt(19)
    s_nop 0
    v_mfma_f32_16x16x32_bf16 v[36:39], v[32:35], a[124:127], v[36:39]
    buffer_load_dwordx4 a[172:175], v1, s[12:15], s3 offen offset:3072 nt
    v_and_b32_dpp v28, v56, v20 row_newbcast:0 row_mask:0xf bank_mask:0xf
    v_and_b32_dpp v29, v56, v21 row_newbcast:0 row_mask:0xf bank_mask:0xf
    v_and_b32_dpp v30, v56, v22 row_newbcast:0 row_mask:0xf bank_mask:0xf
    v_and_b32_dpp v31, v56, v23 row_newbcast:0 row_mask:0xf bank_mask:0xf
    s_waitcnt vmcnt(18)
    s_nop 0
    v_mfma_f32_16x16x32_bf16 v[36:39], v[28:31], a[128:131], v[36:39]
    s_mov_b32 s59, 110592
    buffer_load_dwordx4 v[236:239], v3, s[20:23], s59 offen
    s_mov_b32 s3, 180224
    buffer_load_dwordx4 a[176:179], v1, s[12:15], s3 offen offset:0 nt
    v_and_b32_dpp v32, v56, v20 row_newbcast:4 row_mask:0xf bank_mask:0xf
    v_and_b32_dpp v33, v56, v21 row_newbcast:4 row_mask:0xf bank_mask:0xf
    v_and_b32_dpp v34, v56, v22 row_newbcast:4 row_mask:0xf bank_mask:0xf
    v_and_b32_dpp v35, v56, v23 row_newbcast:4 row_mask:0xf bank_mask:0xf
    s_waitcnt vmcnt(19)
    s_nop 0
    v_mfma_f32_16x16x32_bf16 v[36:39], v[32:35], a[132:135], v[36:39]
    buffer_load_dwordx4 v[100:103], v8, s[36:39], 0 offen sc1
    v_and_b32_dpp v28, v56, v20 row_newbcast:8 row_mask:0xf bank_mask:0xf
    v_and_b32_dpp v29, v56, v21 row_newbcast:8 row_mask:0xf bank_mask:0xf
    v_and_b32_dpp v30, v56, v22 row_newbcast:8 row_mask:0xf bank_mask:0xf
    v_and_b32_dpp v31, v56, v23 row_newbcast:8 row_mask:0xf bank_mask:0xf
    s_waitcnt vmcnt(18)
    s_nop 0
    v_mfma_f32_16x16x32_bf16 v[36:39], v[28:31], a[136:139], v[36:39]
    buffer_load_dwordx4 a[180:183], v1, s[12:15], s3 offen offset:1024 nt
    s_mov_b32 s59, 114688
    buffer_load_dwordx4 v[240:243], v3, s[20:23], s59 offen
    v_and_b32_dpp v32, v56, v20 row_newbcast:12 row_mask:0xf bank_mask:0xf
    v_and_b32_dpp v33, v56, v21 row_newbcast:12 row_mask:0xf bank_mask:0xf
    v_and_b32_dpp v34, v56, v22 row_newbcast:12 row_mask:0xf bank_mask:0xf
    v_and_b32_dpp v35, v56, v23 row_newbcast:12 row_mask:0xf bank_mask:0xf
    s_waitcnt vmcnt(18)
    s_nop 0
    v_mfma_f32_16x16x32_bf16 v[36:39], v[32:35], a[140:143], v[36:39]
    buffer_load_dwordx4 a[184:187], v1, s[12:15], s3 offen offset:2048 nt
    s_mov_b32 s59, 118784
    buffer_load_dwordx4 v[244:247], v3, s[20:23], s59 offen
    v_and_b32_dpp v28, v57, v20 row_newbcast:0 row_mask:0xf bank_mask:0xf
    v_and_b32_dpp v29, v57, v21 row_newbcast:0 row_mask:0xf bank_mask:0xf
    v_and_b32_dpp v30, v57, v22 row_newbcast:0 row_mask:0xf bank_mask:0xf
    v_and_b32_dpp v31, v57, v23 row_newbcast:0 row_mask:0xf bank_mask:0xf
    s_waitcnt vmcnt(19)
    s_nop 0
    v_mfma_f32_16x16x32_bf16 v[36:39], v[28:31], a[144:147], v[36:39]
    buffer_load_dwordx4 a[188:191], v1, s[12:15], s3 offen offset:3072 nt
    v_and_b32_dpp v32, v57, v20 row_newbcast:4 row_mask:0xf bank_mask:0xf
    v_and_b32_dpp v33, v57, v21 row_newbcast:4 row_mask:0xf bank_mask:0xf
    v_and_b32_dpp v34, v57, v22 row_newbcast:4 row_mask:0xf bank_mask:0xf
    v_and_b32_dpp v35, v57, v23 row_newbcast:4 row_mask:0xf bank_mask:0xf
    s_waitcnt vmcnt(18)
    s_nop 0
    v_mfma_f32_16x16x32_bf16 v[36:39], v[32:35], a[148:151], v[36:39]
    s_mov_b32 s3, 196608
    buffer_load_dwordx4 a[192:195], v1, s[12:15], s3 offen offset:0 nt
    s_mov_b32 s59, 122880
    buffer_load_dwordx4 v[248:251], v3, s[20:23], s59 offen
    v_and_b32_dpp v28, v57, v20 row_newbcast:8 row_mask:0xf bank_mask:0xf
    v_and_b32_dpp v29, v57, v21 row_newbcast:8 row_mask:0xf bank_mask:0xf
    v_and_b32_dpp v30, v57, v22 row_newbcast:8 row_mask:0xf bank_mask:0xf
    v_and_b32_dpp v31, v57, v23 row_newbcast:8 row_mask:0xf bank_mask:0xf
    s_waitcnt vmcnt(18)
    s_nop 0
    v_mfma_f32_16x16x32_bf16 v[36:39], v[28:31], a[152:155], v[36:39]
    buffer_load_dwordx4 a[196:199], v1, s[12:15], s3 offen offset:1024 nt
    buffer_load_dwordx4 a[200:203], v1, s[12:15], s3 offen offset:2048 nt
    v_and_b32_dpp v32, v57, v20 row_newbcast:12 row_mask:0xf bank_mask:0xf
    v_and_b32_dpp v33, v57, v21 row_newbcast:12 row_mask:0xf bank_mask:0xf
    v_and_b32_dpp v34, v57, v22 row_newbcast:12 row_mask:0xf bank_mask:0xf
    v_and_b32_dpp v35, v57, v23 row_newbcast:12 row_mask:0xf bank_mask:0xf
    s_waitcnt lgkmcnt(0)
    ds_write_b128 v122, v[192:195] offset:0
    ds_write_b128 v122, v[196:199] offset:1152
    ds_write_b128 v122, v[200:203] offset:2304
    ds_write_b128 v122, v[204:207] offset:3456
    ds_write_b128 v122, v[208:211] offset:4608
    ds_write_b128 v122, v[212:215] offset:5760
    ds_write_b128 v122, v[216:219] offset:6912
    ds_write_b128 v122, v[220:223] offset:8064
    s_waitcnt lgkmcnt(0)
    ds_read_b64_tr_b16 v[192:193], v123 offset:0
    ds_read_b64_tr_b16 v[194:195], v123 offset:1152
    ds_read_b64_tr_b16 v[196:197], v123 offset:32
    ds_read_b64_tr_b16 v[198:199], v123 offset:1184
    ds_read_b64_tr_b16 v[200:201], v123 offset:64
    ds_read_b64_tr_b16 v[202:203], v123 offset:1216
    ds_read_b64_tr_b16 v[204:205], v123 offset:96
    ds_read_b64_tr_b16 v[206:207], v123 offset:1248
    ds_read_b64_tr_b16 v[208:209], v123 offset:128
    ds_read_b64_tr_b16 v[210:211], v123 offset:1280
    ds_read_b64_tr_b16 v[212:213], v123 offset:160
    ds_read_b64_tr_b16 v[214:215], v123 offset:1312
    ds_read_b64_tr_b16 v[216:217], v123 offset:192
    ds_read_b64_tr_b16 v[218:219], v123 offset:1344
    ds_read_b64_tr_b16 v[220:221], v123 offset:224
    ds_read_b64_tr_b16 v[222:223], v123 offset:1376
    s_waitcnt vmcnt(19)
    v_mfma_f32_16x16x32_bf16 v[36:39], v[32:35], a[156:159], v[36:39]
    s_mov_b32 s59, 126976
    buffer_load_dwordx4 v[252:255], v3, s[20:23], s59 offen
    v_and_b32_dpp v28, v58, v20 row_newbcast:0 row_mask:0xf bank_mask:0xf
    v_and_b32_dpp v29, v58, v21 row_newbcast:0 row_mask:0xf bank_mask:0xf
    v_and_b32_dpp v30, v58, v22 row_newbcast:0 row_mask:0xf bank_mask:0xf
    v_and_b32_dpp v31, v58, v23 row_newbcast:0 row_mask:0xf bank_mask:0xf
    s_waitcnt vmcnt(18)
    s_nop 0
    v_mfma_f32_16x16x32_bf16 v[36:39], v[28:31], a[160:163], v[36:39]
    buffer_load_dwordx4 a[204:207], v1, s[12:15], s3 offen offset:3072 nt
    s_mov_b32 s3, 212992
    buffer_load_dwordx4 a[208:211], v1, s[12:15], s3 offen offset:0 nt
    v_and_b32_dpp v32, v58, v20 row_newbcast:4 row_mask:0xf bank_mask:0xf
    v_and_b32_dpp v33, v58, v21 row_newbcast:4 row_mask:0xf bank_mask:0xf
    v_and_b32_dpp v34, v58, v22 row_newbcast:4 row_mask:0xf bank_mask:0xf
    v_and_b32_dpp v35, v58, v23 row_newbcast:4 row_mask:0xf bank_mask:0xf
    s_waitcnt vmcnt(18)
    s_nop 0
    v_mfma_f32_16x16x32_bf16 v[36:39], v[32:35], a[164:167], v[36:39]
    buffer_load_dwordx4 a[212:215], v1, s[12:15], s3 offen offset:1024 nt
    buffer_load_dwordx4 a[216:219], v1, s[12:15], s3 offen offset:2048 nt
    v_and_b32_dpp v28, v58, v20 row_newbcast:8 row_mask:0xf bank_mask:0xf
    v_and_b32_dpp v29, v58, v21 row_newbcast:8 row_mask:0xf bank_mask:0xf
    v_and_b32_dpp v30, v58, v22 row_newbcast:8 row_mask:0xf bank_mask:0xf
    v_and_b32_dpp v31, v58, v23 row_newbcast:8 row_mask:0xf bank_mask:0xf
    s_waitcnt vmcnt(19)
    s_nop 0
    v_mfma_f32_16x16x32_bf16 v[36:39], v[28:31], a[168:171], v[36:39]
    buffer_load_dwordx4 a[220:223], v1, s[12:15], s3 offen offset:3072 nt
    v_and_b32_dpp v32, v58, v20 row_newbcast:12 row_mask:0xf bank_mask:0xf
    v_and_b32_dpp v33, v58, v21 row_newbcast:12 row_mask:0xf bank_mask:0xf
    v_and_b32_dpp v34, v58, v22 row_newbcast:12 row_mask:0xf bank_mask:0xf
    v_and_b32_dpp v35, v58, v23 row_newbcast:12 row_mask:0xf bank_mask:0xf
    s_waitcnt vmcnt(18)
    s_nop 0
    v_mfma_f32_16x16x32_bf16 v[36:39], v[32:35], a[172:175], v[36:39]
    s_mov_b32 s3, 229376
    buffer_load_dwordx4 a[224:227], v1, s[12:15], s3 offen offset:0 nt
    buffer_load_dwordx4 a[228:231], v1, s[12:15], s3 offen offset:1024 nt
    v_and_b32_dpp v28, v59, v20 row_newbcast:0 row_mask:0xf bank_mask:0xf
    v_and_b32_dpp v29, v59, v21 row_newbcast:0 row_mask:0xf bank_mask:0xf
    v_and_b32_dpp v30, v59, v22 row_newbcast:0 row_mask:0xf bank_mask:0xf
    v_and_b32_dpp v31, v59, v23 row_newbcast:0 row_mask:0xf bank_mask:0xf
    s_waitcnt vmcnt(18)
    s_nop 0
    v_mfma_f32_16x16x32_bf16 v[36:39], v[28:31], a[176:179], v[36:39]
    buffer_load_dwordx4 a[232:235], v1, s[12:15], s3 offen offset:2048 nt
    buffer_load_dwordx4 a[236:239], v1, s[12:15], s3 offen offset:3072 nt
    v_and_b32_dpp v32, v59, v20 row_newbcast:4 row_mask:0xf bank_mask:0xf
    v_and_b32_dpp v33, v59, v21 row_newbcast:4 row_mask:0xf bank_mask:0xf
    v_and_b32_dpp v34, v59, v22 row_newbcast:4 row_mask:0xf bank_mask:0xf
    v_and_b32_dpp v35, v59, v23 row_newbcast:4 row_mask:0xf bank_mask:0xf
    s_waitcnt vmcnt(18)
    s_nop 0
    v_mfma_f32_16x16x32_bf16 v[36:39], v[32:35], a[180:183], v[36:39]
    s_mov_b32 s3, 245760
    buffer_load_dwordx4 a[240:243], v1, s[12:15], s3 offen offset:0 nt
    buffer_load_dwordx4 a[244:247], v1, s[12:15], s3 offen offset:1024 nt
    v_and_b32_dpp v28, v59, v20 row_newbcast:8 row_mask:0xf bank_mask:0xf
    v_and_b32_dpp v29, v59, v21 row_newbcast:8 row_mask:0xf bank_mask:0xf
    v_and_b32_dpp v30, v59, v22 row_newbcast:8 row_mask:0xf bank_mask:0xf
    v_and_b32_dpp v31, v59, v23 row_newbcast:8 row_mask:0xf bank_mask:0xf
    v_and_b32 v119, 0xfff, v18
    v_bfe_u32 v44, v0, 5, 1
    v_lshlrev_b32 v120, 18, v44
    v_and_b32 v44, 31, v0
    v_lshl_add_u32 v120, v44, 11, v120
    v_lshrrev_b32 v45, 6, v0
    v_lshl_add_u32 v120, v45, 4, v120
    s_lshl_b32 s57, s53, 20
    s_lshl_b32 s58, s52, 6
    s_add_u32 s57, s57, s58
    v_add_u32 v120, s57, v120
    s_mov_b32 s80, 524288
    v_bfe_u32 v44, v0, 2, 2
    v_lshl_add_u32 v44, v45, 2, v44
    s_lshl_b32 s57, s52, 4
    v_add_u32 v44, s57, v44
    v_and_b32 v46, 0x1e0, v44
    v_and_b32 v47, 1, v44
    v_lshl_add_u32 v46, v47, 4, v46
    v_bfe_u32 v47, v44, 1, 4
    v_add_lshl_u32 v44, v46, v47, 1
    s_lshl_b32 s57, s53, 10
    v_add_u32 v44, s57, v44
    v_and_b32 v46, 0x33, v0
    v_mov_b32 v47, 1073741824
    v_cmp_eq_u32 vcc, 0, v46
    s_nop 1
    v_cndmask_b32 v121, v47, v44, vcc
    v_xor_b32 v44, v102, v18
    v_xor_b32 v45, v103, v19
    v_or_b32 v44, v44, v45
    v_cmp_ne_u32 vcc, 0, v44
    s_nop 0
    s_cbranch_vccz L_ml_ok
    s_mov_b32 s61, 1048576
L_ml_spin:
    s_nop 4
    buffer_load_dwordx4 v[100:103], v8, s[36:39], 0 offen sc1
    s_waitcnt vmcnt(0)
    v_xor_b32 v44, v102, v18
    v_xor_b32 v45, v103, v19
    v_or_b32 v44, v44, v45
    v_cmp_ne_u32 vcc, 0, v44
    s_nop 0
    s_cbranch_vccz L_ml_ok
    s_sub_u32 s61, s61, 1
    s_cmp_lg_u32 s61, 0
    s_cbranch_scc1 L_ml_spin
L_ml_ok:
    s_nop 4
    v_max_f32_dpp v44, v100, v100 quad_perm:[1,0,3,2] row_mask:0xf bank_mask:0xf
    s_nop 1
    v_max_f32_dpp v44, v44, v44 quad_perm:[2,3,0,1] row_mask:0xf bank_mask:0xf
    v_sub_f32 v45, v100, v44
    v_sub_f32 v46, v16, v44
    v_exp_f32 v45, v45
    v_exp_f32 v46, v46
    v_mul_f32 v45, v45, v101
    s_nop 1
    v_add_f32_dpp v45, v45, v45 quad_perm:[1,0,3,2] row_mask:0xf bank_mask:0xf
    s_nop 1
    v_add_f32_dpp v45, v45, v45 quad_perm:[2,3,0,1] row_mask:0xf bank_mask:0xf
    v_rcp_f32 v45, v45
    v_mul_f32 v46, v46, v11
    v_mul_f32 v15, v46, v45
    s_waitcnt vmcnt(18)
    v_mfma_f32_16x16x32_bf16 v[36:39], v[28:31], a[184:187], v[36:39]
    buffer_load_dwordx4 a[248:251], v1, s[12:15], s3 offen offset:2048 nt
    buffer_load_dwordx4 a[252:255], v1, s[12:15], s3 offen offset:3072 nt
    v_and_b32_dpp v32, v59, v20 row_newbcast:12 row_mask:0xf bank_mask:0xf
    v_and_b32_dpp v33, v59, v21 row_newbcast:12 row_mask:0xf bank_mask:0xf
    v_and_b32_dpp v34, v59, v22 row_newbcast:12 row_mask:0xf bank_mask:0xf
    v_and_b32_dpp v35, v59, v23 row_newbcast:12 row_mask:0xf bank_mask:0xf
    s_waitcnt vmcnt(18)
    s_nop 0
    v_mfma_f32_16x16x32_bf16 v[36:39], v[32:35], a[188:191], v[36:39]
    v_and_b32_dpp v28, v60, v20 row_newbcast:0 row_mask:0xf bank_mask:0xf
    v_and_b32_dpp v29, v60, v21 row_newbcast:0 row_mask:0xf bank_mask:0xf
    v_and_b32_dpp v30, v60, v22 row_newbcast:0 row_mask:0xf bank_mask:0xf
    v_and_b32_dpp v31, v60, v23 row_newbcast:0 row_mask:0xf bank_mask:0xf
    s_waitcnt vmcnt(17)
    s_nop 0
    v_mfma_f32_16x16x32_bf16 v[36:39], v[28:31], a[192:195], v[36:39]
    v_and_b32_dpp v32, v60, v20 row_newbcast:4 row_mask:0xf bank_mask:0xf
    v_and_b32_dpp v33, v60, v21 row_newbcast:4 row_mask:0xf bank_mask:0xf
    v_and_b32_dpp v34, v60, v22 row_newbcast:4 row_mask:0xf bank_mask:0xf
    v_and_b32_dpp v35, v60, v23 row_newbcast:4 row_mask:0xf bank_mask:0xf
    s_waitcnt vmcnt(15)
    s_nop 0
    v_mfma_f32_16x16x32_bf16 v[36:39], v[32:35], a[196:199], v[36:39]
    v_and_b32_dpp v28, v60, v20 row_newbcast:8 row_mask:0xf bank_mask:0xf
    v_and_b32_dpp v29, v60, v21 row_newbcast:8 row_mask:0xf bank_mask:0xf
    v_and_b32_dpp v30, v60, v22 row_newbcast:8 row_mask:0xf bank_mask:0xf
    v_and_b32_dpp v31, v60, v23 row_newbcast:8 row_mask:0xf bank_mask:0xf
    s_waitcnt vmcnt(14)
    s_nop 0
    v_mfma_f32_16x16x32_bf16 v[36:39], v[28:31], a[200:203], v[36:39]
    v_and_b32_dpp v32, v60, v20 row_newbcast:12 row_mask:0xf bank_mask:0xf
    v_and_b32_dpp v33, v60, v21 row_newbcast:12 row_mask:0xf bank_mask:0xf
    v_and_b32_dpp v34, v60, v22 row_newbcast:12 row_mask:0xf bank_mask:0xf
    v_and_b32_dpp v35, v60, v23 row_newbcast:12 row_mask:0xf bank_mask:0xf
    s_waitcnt vmcnt(12)
    s_nop 0
    v_mfma_f32_16x16x32_bf16 v[36:39], v[32:35], a[204:207], v[36:39]
    v_and_b32_dpp v28, v61, v20 row_newbcast:0 row_mask:0xf bank_mask:0xf
    v_and_b32_dpp v29, v61, v21 row_newbcast:0 row_mask:0xf bank_mask:0xf
    v_and_b32_dpp v30, v61, v22 row_newbcast:0 row_mask:0xf bank_mask:0xf
    v_and_b32_dpp v31, v61, v23 row_newbcast:0 row_mask:0xf bank_mask:0xf
    s_waitcnt lgkmcnt(0)
    ds_write_b128 v122, v[224:227] offset:0
    ds_write_b128 v122, v[228:231] offset:1152
    ds_write_b128 v122, v[232:235] offset:2304
    ds_write_b128 v122, v[236:239] offset:3456
    ds_write_b128 v122, v[240:243] offset:4608
    ds_write_b128 v122, v[244:247] offset:5760
    ds_write_b128 v122, v[248:251] offset:6912
    ds_write_b128 v122, v[252:255] offset:8064
    s_waitcnt lgkmcnt(0)
    ds_read_b64_tr_b16 v[224:225], v123 offset:0
    ds_read_b64_tr_b16 v[226:227], v123 offset:1152
    ds_read_b64_tr_b16 v[228:229], v123 offset:32
    ds_read_b64_tr_b16 v[230:231], v123 offset:1184
    ds_read_b64_tr_b16 v[232:233], v123 offset:64
    ds_read_b64_tr_b16 v[234:235], v123 offset:1216
    ds_read_b64_tr_b16 v[236:237], v123 offset:96
    ds_read_b64_tr_b16 v[238:239], v123 offset:1248
    ds_read_b64_tr_b16 v[240:241], v123 offset:128
    ds_read_b64_tr_b16 v[242:243], v123 offset:1280
    ds_read_b64_tr_b16 v[244:245], v123 offset:160
    ds_read_b64_tr_b16 v[246:247], v123 offset:1312
    ds_read_b64_tr_b16 v[248:249], v123 offset:192
    ds_read_b64_tr_b16 v[250:251], v123 offset:1344
    ds_read_b64_tr_b16 v[252:253], v123 offset:224
    ds_read_b64_tr_b16 v[254:255], v123 offset:1376
    s_waitcnt vmcnt(11)
    v_mfma_f32_16x16x32_bf16 v[36:39], v[28:31], a[208:211], v[36:39]
    v_and_b32_dpp v32, v61, v20 row_newbcast:4 row_mask:0xf bank_mask:0xf
    v_and_b32_dpp v33, v61, v21 row_newbcast:4 row_mask:0xf bank_mask:0xf
    v_and_b32_dpp v34, v61, v22 row_newbcast:4 row_mask:0xf bank_mask:0xf
    v_and_b32_dpp v35, v61, v23 row_newbcast:4 row_mask:0xf bank_mask:0xf
    s_waitcnt vmcnt(10)
    s_nop 0
    v_mfma_f32_16x16x32_bf16 v[36:39], v[32:35], a[212:215], v[36:39]
    v_and_b32_dpp v28, v61, v20 row_newbcast:8 row_mask:0xf bank_mask:0xf
    v_and_b32_dpp v29, v61, v21 row_newbcast:8 row_mask:0xf bank_mask:0xf
    v_and_b32_dpp v30, v61, v22 row_newbcast:8 row_mask:0xf bank_mask:0xf
    v_and_b32_dpp v31, v61, v23 row_newbcast:8 row_mask:0xf bank_mask:0xf
    s_waitcnt vmcnt(9)
    s_nop 0
    v_mfma_f32_16x16x32_bf16 v[36:39], v[28:31], a[216:219], v[36:39]
    v_and_b32_dpp v32, v61, v20 row_newbcast:12 row_mask:0xf bank_mask:0xf
    v_and_b32_dpp v33, v61, v21 row_newbcast:12 row_mask:0xf bank_mask:0xf
    v_and_b32_dpp v34, v61, v22 row_newbcast:12 row_mask:0xf bank_mask:0xf
    v_and_b32_dpp v35, v61, v23 row_newbcast:12 row_mask:0xf bank_mask:0xf
    s_waitcnt vmcnt(8)
    s_nop 0
    v_mfma_f32_16x16x32_bf16 v[36:39], v[32:35], a[220:223], v[36:39]
    v_and_b32_dpp v28, v62, v20 row_newbcast:0 row_mask:0xf bank_mask:0xf
    v_and_b32_dpp v29, v62, v21 row_newbcast:0 row_mask:0xf bank_mask:0xf
    v_and_b32_dpp v30, v62, v22 row_newbcast:0 row_mask:0xf bank_mask:0xf
    v_and_b32_dpp v31, v62, v23 row_newbcast:0 row_mask:0xf bank_mask:0xf
    s_waitcnt vmcnt(7)
    s_nop 0
    v_mfma_f32_16x16x32_bf16 v[36:39], v[28:31], a[224:227], v[36:39]
    v_and_b32_dpp v32, v62, v20 row_newbcast:4 row_mask:0xf bank_mask:0xf
    v_and_b32_dpp v33, v62, v21 row_newbcast:4 row_mask:0xf bank_mask:0xf
    v_and_b32_dpp v34, v62, v22 row_newbcast:4 row_mask:0xf bank_mask:0xf
    v_and_b32_dpp v35, v62, v23 row_newbcast:4 row_mask:0xf bank_mask:0xf
    s_waitcnt vmcnt(6)
    s_nop 0
    v_mfma_f32_16x16x32_bf16 v[36:39], v[32:35], a[228:231], v[36:39]
    v_and_b32_dpp v28, v62, v20 row_newbcast:8 row_mask:0xf bank_mask:0xf
    v_and_b32_dpp v29, v62, v21 row_newbcast:8 row_mask:0xf bank_mask:0xf
    v_and_b32_dpp v30, v62, v22 row_newbcast:8 row_mask:0xf bank_mask:0xf
    v_and_b32_dpp v31, v62, v23 row_newbcast:8 row_mask:0xf bank_mask:0xf
    s_waitcnt vmcnt(5)
    s_nop 0
    v_mfma_f32_16x16x32_bf16 v[36:39], v[28:31], a[232:235], v[36:39]
    v_and_b32_dpp v32, v62, v20 row_newbcast:12 row_mask:0xf bank_mask:0xf
    v_and_b32_dpp v33, v62, v21 row_newbcast:12 row_mask:0xf bank_mask:0xf
    v_and_b32_dpp v34, v62, v22 row_newbcast:12 row_mask:0xf bank_mask:0xf
    v_and_b32_dpp v35, v62, v23 row_newbcast:12 row_mask:0xf bank_mask:0xf
    s_waitcnt vmcnt(4)
    s_nop 0
    v_mfma_f32_16x16x32_bf16 v[36:39], v[32:35], a[236:239], v[36:39]
    v_and_b32_dpp v28, v63, v20 row_newbcast:0 row_mask:0xf bank_mask:0xf
    v_and_b32_dpp v29, v63, v21 row_newbcast:0 row_mask:0xf bank_mask:0xf
    v_and_b32_dpp v30, v63, v22 row_newbcast:0 row_mask:0xf bank_mask:0xf
    v_and_b32_dpp v31, v63, v23 row_newbcast:0 row_mask:0xf bank_mask:0xf
    s_waitcnt vmcnt(3)
    s_nop 0
    v_mfma_f32_16x16x32_bf16 v[36:39], v[28:31], a[240:243], v[36:39]
    v_and_b32_dpp v32, v63, v20 row_newbcast:4 row_mask:0xf bank_mask:0xf
    v_and_b32_dpp v33, v63, v21 row_newbcast:4 row_mask:0xf bank_mask:0xf
    v_and_b32_dpp v34, v63, v22 row_newbcast:4 row_mask:0xf bank_mask:0xf
    v_and_b32_dpp v35, v63, v23 row_newbcast:4 row_mask:0xf bank_mask:0xf
    s_waitcnt vmcnt(2)
    s_nop 0
    v_mfma_f32_16x16x32_bf16 v[36:39], v[32:35], a[244:247], v[36:39]
    v_and_b32_dpp v28, v63, v20 row_newbcast:8 row_mask:0xf bank_mask:0xf
    v_and_b32_dpp v29, v63, v21 row_newbcast:8 row_mask:0xf bank_mask:0xf
    v_and_b32_dpp v30, v63, v22 row_newbcast:8 row_mask:0xf bank_mask:0xf
    v_and_b32_dpp v31, v63, v23 row_newbcast:8 row_mask:0xf bank_mask:0xf
    s_waitcnt vmcnt(1)
    s_nop 0
    v_mfma_f32_16x16x32_bf16 v[36:39], v[28:31], a[248:251], v[36:39]
    v_and_b32_dpp v32, v63, v20 row_newbcast:12 row_mask:0xf bank_mask:0xf
    v_and_b32_dpp v33, v63, v21 row_newbcast:12 row_mask:0xf bank_mask:0xf
    v_and_b32_dpp v34, v63, v22 row_newbcast:12 row_mask:0xf bank_mask:0xf
    v_and_b32_dpp v35, v63, v23 row_newbcast:12 row_mask:0xf bank_mask:0xf
    s_waitcnt vmcnt(0)
    s_nop 0
    v_mfma_f32_16x16x32_bf16 v[36:39], v[32:35], a[252:255], v[36:39]
    s_nop 7
    v_mul_f32 v36, v36, v15
    v_mul_f32 v37, v37, v15
    v_mul_f32 v38, v38, v15
    v_mul_f32 v39, v39, v15
    v_cvt_pk_bf16_f32 v36, v36, v37
    v_cvt_pk_bf16_f32 v37, v38, v39
    s_mov_b32 exec_hi, 0
    ds_write_b64 v9, v[36:37] offset:4096
    s_mov_b32 exec_hi, -1
    s_waitcnt lgkmcnt(0)
    s_barrier
    ds_read_b128 v[96:99], v118 offset:4096
    ds_read_b128 v[100:103], v118 offset:4160
    ds_read_b128 v[104:107], v118 offset:4224
    ds_read_b128 v[108:111], v118 offset:4288
    s_waitcnt lgkmcnt(3)
    v_mfma_f32_16x16x32_bf16 v[64:67], v[96:99], v[128:131], 0
    v_mfma_f32_16x16x32_bf16 v[68:71], v[96:99], v[132:135], 0
    v_mfma_f32_16x16x32_bf16 v[72:75], v[96:99], v[136:139], 0
    v_mfma_f32_16x16x32_bf16 v[76:79], v[96:99], v[140:143], 0
    v_mfma_f32_16x16x32_bf16 v[80:83], v[96:99], v[144:147], 0
    v_mfma_f32_16x16x32_bf16 v[84:87], v[96:99], v[148:151], 0
    v_mfma_f32_16x16x32_bf16 v[88:91], v[96:99], v[152:155], 0
    v_mfma_f32_16x16x32_bf16 v[92:95], v[96:99], v[156:159], 0
    s_waitcnt lgkmcnt(2)
    v_mfma_f32_16x16x32_bf16 v[64:67], v[100:103], v[160:163], v[64:67]
    v_mfma_f32_16x16x32_bf16 v[68:71], v[100:103], v[164:167], v[68:71]
    v_mfma_f32_16x16x32_bf16 v[72:75], v[100:103], v[168:171], v[72:75]
    v_mfma_f32_16x16x32_bf16 v[76:79], v[100:103], v[172:175], v[76:79]
    v_mfma_f32_16x16x32_bf16 v[80:83], v[100:103], v[176:179], v[80:83]
    v_mfma_f32_16x16x32_bf16 v[84:87], v[100:103], v[180:183], v[84:87]
    v_mfma_f32_16x16x32_bf16 v[88:91], v[100:103], v[184:187], v[88:91]
    v_mfma_f32_16x16x32_bf16 v[92:95], v[100:103], v[188:191], v[92:95]
    s_waitcnt lgkmcnt(1)
    v_mfma_f32_16x16x32_bf16 v[64:67], v[104:107], v[192:195], v[64:67]
    v_mfma_f32_16x16x32_bf16 v[68:71], v[104:107], v[196:199], v[68:71]
    v_mfma_f32_16x16x32_bf16 v[72:75], v[104:107], v[200:203], v[72:75]
    v_mfma_f32_16x16x32_bf16 v[76:79], v[104:107], v[204:207], v[76:79]
    v_mfma_f32_16x16x32_bf16 v[80:83], v[104:107], v[208:211], v[80:83]
    v_mfma_f32_16x16x32_bf16 v[84:87], v[104:107], v[212:215], v[84:87]
    v_mfma_f32_16x16x32_bf16 v[88:91], v[104:107], v[216:219], v[88:91]
    v_mfma_f32_16x16x32_bf16 v[92:95], v[104:107], v[220:223], v[92:95]
    s_waitcnt lgkmcnt(0)
    v_mfma_f32_16x16x32_bf16 v[64:67], v[108:111], v[224:227], v[64:67]
    v_mfma_f32_16x16x32_bf16 v[68:71], v[108:111], v[228:231], v[68:71]
    v_mfma_f32_16x16x32_bf16 v[72:75], v[108:111], v[232:235], v[72:75]
    v_mfma_f32_16x16x32_bf16 v[76:79], v[108:111], v[236:239], v[76:79]
    v_mfma_f32_16x16x32_bf16 v[80:83], v[108:111], v[240:243], v[80:83]
    v_mfma_f32_16x16x32_bf16 v[84:87], v[108:111], v[244:247], v[84:87]
    v_mfma_f32_16x16x32_bf16 v[88:91], v[108:111], v[248:251], v[88:91]
    v_mfma_f32_16x16x32_bf16 v[92:95], v[108:111], v[252:255], v[92:95]
    s_nop 0
    v_pk_add_f32 v[64:65], v[64:65], v[66:67]
    v_pk_add_f32 v[68:69], v[68:69], v[70:71]
    v_pk_add_f32 v[72:73], v[72:73], v[74:75]
    v_pk_add_f32 v[76:77], v[76:77], v[78:79]
    v_pk_add_f32 v[80:81], v[80:81], v[82:83]
    v_pk_add_f32 v[84:85], v[84:85], v[86:87]
    v_pk_add_f32 v[88:89], v[88:89], v[90:91]
    v_pk_add_f32 v[92:93], v[92:93], v[94:95]
    v_add_f32_dpp v36, v64, v65 quad_perm:[0,1,2,3] row_mask:0x1 bank_mask:0xf
    v_add_f32_dpp v37, v68, v69 quad_perm:[0,1,2,3] row_mask:0x1 bank_mask:0xf
    s_nop 0
    v_add_f32_dpp v36, v72, v73 quad_perm:[0,1,2,3] row_mask:0x2 bank_mask:0xf
    v_add_f32_dpp v37, v76, v77 quad_perm:[0,1,2,3] row_mask:0x2 bank_mask:0xf
    s_nop 0
    v_add_f32_dpp v36, v80, v81 quad_perm:[0,1,2,3] row_mask:0x4 bank_mask:0xf
    v_add_f32_dpp v37, v84, v85 quad_perm:[0,1,2,3] row_mask:0x4 bank_mask:0xf
    s_nop 0
    v_add_f32_dpp v36, v88, v89 quad_perm:[0,1,2,3] row_mask:0x8 bank_mask:0xf
    v_add_f32_dpp v37, v92, v93 quad_perm:[0,1,2,3] row_mask:0x8 bank_mask:0xf
    v_pk_add_f32 v[36:37], v[36:37], v[116:117]
    v_and_or_b32 v36, v36, s88, v119
    v_and_or_b32 v37, v37, s88, v119
    buffer_store_dwordx2 v[36:37], v6, s[36:39], 0 offen sc1
    s_cmp_lg_u32 s54, 0
    s_cbranch_scc1 L_notcons
    s_mov_b64 s[64:65], -1
    s_mov_b64 s[66:67], -1
    s_mov_b32 s61, 1048576
L_slow:
    s_mov_b64 exec, s[64:65]
    buffer_load_dwordx4 v[96:99], v120, s[36:39], 0 offen sc1
    s_mov_b64 exec, s[66:67]
    buffer_load_dwordx4 v[100:103], v120, s[36:39], s80 offen sc1
    s_mov_b64 exec, -1
    s_sub_u32 s61, s61, 1
    s_waitcnt vmcnt(1)
    v_xor_b32 v64, v96, v119
    v_xor_b32 v65, v97, v119
    v_xor_b32 v66, v98, v119
    v_xor_b32 v67, v99, v119
    v_or3_b32 v46, v64, v65, v66
    v_bitop3_b32 v46, v46, v67, s89 bitop3:0xa8
    v_cmp_ne_u32 s[64:65], 0, v46
    s_waitcnt vmcnt(0)
    v_xor_b32 v68, v100, v119
    v_xor_b32 v69, v101, v119
    v_xor_b32 v70, v102, v119
    v_xor_b32 v71, v103, v119
    v_or3_b32 v46, v68, v69, v70
    v_bitop3_b32 v46, v46, v71, s89 bitop3:0xa8
    v_cmp_ne_u32 s[66:67], 0, v46
    v_pk_add_f32 v[64:65], v[64:65], v[68:69]
    s_or_b64 vcc, s[64:65], s[66:67]
    s_cbranch_scc0 L_got
    s_cmp_lg_u32 s61, 0
    s_cbranch_scc1 L_slow
L_got:
    v_pk_add_f32 v[66:67], v[66:67], v[70:71]
    v_add_f32_dpp v64, v64, v64 row_ror:8 row_mask:0xf bank_mask:0x3
    v_add_f32_dpp v65, v65, v65 row_ror:8 row_mask:0xf bank_mask:0x3
    s_nop 0
    v_add_f32_dpp v64, v66, v66 row_ror:8 row_mask:0xf bank_mask:0xc
    v_add_f32_dpp v65, v67, v67 row_ror:8 row_mask:0xf bank_mask:0xc
    s_nop 0
    v_add_f32_dpp v64, v64, v64 row_half_mirror row_mask:0xf bank_mask:0x5
    s_nop 1
    v_add_f32_dpp v64, v65, v65 row_half_mirror row_mask:0xf bank_mask:0xa
    s_nop 1
    v_add_f32_dpp v64, v64, v64 quad_perm:[1,0,3,2] row_mask:0xf bank_mask:0xf
    s_nop 1
    v_add_f32_dpp v64, v64, v64 quad_perm:[2,3,0,1] row_mask:0xf bank_mask:0xf
    v_mov_b32 v65, v64
    s_nop 1
    v_permlane32_swap_b32 v64, v65
    v_add_f32 v64, v64, v65
    v_mov_b32 v65, v64
    s_nop 1
    v_permlane16_swap_b32 v64, v65
    v_add_f32 v64, v64, v65
    v_cvt_pk_bf16_f32 v64, v64, v64
    buffer_store_short v64, v121, s[32:35], 0 offen
    s_branch L_fin
L_notcons:
    s_or_b32 s57, s47, s55
    s_cmp_lg_u32 s57, 256
    s_cbranch_scc1 L_fin
    v_and_b32 v44, 63, v0
    v_and_b32 v45, 7, v44
    v_lshrrev_b32 v44, 3, v44
    v_lshlrev_b32 v44, 7, v44
    v_lshl_add_u32 v44, v45, 18, v44
    v_add_u32 v44, 98304, v44
    s_mov_b32 s61, 1048576
L_ver:
    s_mov_b32 s59, 0
    buffer_load_dwordx4 v[64:67], v44, s[36:39], s59 offen sc1
    s_mov_b32 s59, 1024
    buffer_load_dwordx4 v[68:71], v44, s[36:39], s59 offen sc1
    s_mov_b32 s59, 2048
    buffer_load_dwordx4 v[72:75], v44, s[36:39], s59 offen sc1
    s_mov_b32 s59, 3072
    buffer_load_dwordx4 v[76:79], v44, s[36:39], s59 offen sc1
    s_sub_u32 s61, s61, 1
    s_waitcnt vmcnt(0)
    v_xor_b32 v66, v66, v18
    v_xor_b32 v67, v67, v19
    v_xor_b32 v70, v70, v18
    v_xor_b32 v71, v71, v19
    v_xor_b32 v74, v74, v18
    v_xor_b32 v75, v75, v19
    v_xor_b32 v78, v78, v18
    v_xor_b32 v79, v79, v19
    v_or3_b32 v46, v66, v67, v70
    v_or3_b32 v46, v46, v71, v74
    v_or3_b32 v46, v46, v75, v78
    v_or_b32 v46, v46, v79
    v_cmp_ne_u32 vcc, 0, v46
    s_nop 0
    s_cbranch_vccz L_verok
    s_cmp_lg_u32 s61, 0
    s_cbranch_scc1 L_ver
L_verok:
    v_add_u32 v46, 0x61c88648, v18
    s_mov_b32 s59, 131072
    buffer_store_dword v46, off, s[36:39], s59 sc1
L_fin:
L_end:
    s_endpgm
.section .rodata,"a"
.p2align 6
.amdhsa_kernel gated_mix__mha_block_cached__geglu_ffn__decode_kernel
  .amdhsa_next_free_vgpr 512
  .amdhsa_next_free_sgpr 102
  .amdhsa_accum_offset 256
  .amdhsa_group_segment_fixed_size 0
  .amdhsa_kernarg_size 104
  .amdhsa_user_sgpr_count 2
  .amdhsa_user_sgpr_kernarg_segment_ptr 1
  .amdhsa_system_sgpr_workgroup_id_x 1
.end_amdhsa_kernel
```
